```python
import torch

def _softmax(x, axis=-1):
    return torch.softmax(x, dim=axis)
def _gelu(x):
    return torch.nn.functional.gelu(x, approximate="tanh")
def _silu(x):
    return torch.nn.functional.silu(x)
def _sigmoid(x):
    return torch.sigmoid(x)
def _layernorm(x, axis=-1, eps=1e-5):
    m = x.mean(dim=axis, keepdim=True)
    v = x.var(dim=axis, keepdim=True, unbiased=False)
    return (x - m) / torch.sqrt(v + eps)
def _scatter_add(tgt, idx, src, axis=0):
    return tgt.clone().index_add_(axis, idx, src)
def _segment_sum(src, seg, n):
    out = torch.zeros((n,) + src.shape[1:], dtype=src.dtype)
    return out.index_add_(0, seg, src)
def _pad(x, pw):
    flat = tuple(v for pair in reversed(pw) for v in pair)
    return torch.nn.functional.pad(x, flat)

kernel_name = 'parallel_sum__grouped_kv_mqa__mixer_channel_mlp__prompt'

def setup_inputs():

    _w = (lambda a: (lambda t: t.to(torch.bfloat16) if t.is_floating_point() else t)(torch.as_tensor(a)))
    def _A_setup():
        B, S, D, H = 1, 2048, 576, 32
        Dh = D // H
        return {
            "x": _w((lambda *s: torch.randn(*s, dtype=torch.bfloat16) * 0.05)(B, S, D)),
            "wq": _w((lambda *s: torch.randn(*s, dtype=torch.bfloat16) * 0.05)(D, H * Dh)),
            "wk": _w((lambda *s: torch.randn(*s, dtype=torch.bfloat16) * 0.05)(D, Dh)),
            "wv": _w((lambda *s: torch.randn(*s, dtype=torch.bfloat16) * 0.05)(D, Dh)),
            "wo": _w((lambda *s: torch.randn(*s, dtype=torch.bfloat16) * 0.05)(H * Dh, D)),
        }
    _A_in = _A_setup()

    def _B_setup():
        B, S, D, F = 1, 2048, 576, 4608
        return {
            "x": _w((lambda *s: torch.randn(*s, dtype=torch.bfloat16) * 0.05)(B, S, D)),
            "w1": _w((lambda *s: torch.randn(*s, dtype=torch.bfloat16) * 3.2)(D, F) * (D ** -0.5)),
            "b1": _w((lambda *s: torch.randn(*s, dtype=torch.bfloat16) * 0.8)(F)),
            "w2": _w((lambda *s: torch.randn(*s, dtype=torch.bfloat16) * 0.1)(F, D) * (F ** -0.5)),
            "b2": _w((lambda *s: torch.randn(*s, dtype=torch.bfloat16) * 0.1)(D)),
        }
    _B_in = _B_setup()

    return {
        "A_x": _A_in["x"],
        "A_wq": _A_in["wq"],
        "A_wk": _A_in["wk"],
        "A_wv": _A_in["wv"],
        "A_wo": _A_in["wo"],
        "B_x": _B_in["x"],
        "B_w1": _B_in["w1"],
        "B_b1": _B_in["b1"],
        "B_w2": _B_in["w2"],
        "B_b2": _B_in["b2"],
    }

def reference(A_x, A_wq, A_wk, A_wv, A_wo, B_x, B_w1, B_b1, B_w2, B_b2):
    def _A_ref(x, wq, wk, wv, wo):
        B, S, D = x.shape
        H = 32
        Dh = D // H
        q = (lambda x, *d: x.permute(*d))((x @ wq).reshape(B, S, H, Dh), 0, 2, 1, 3)
        k = x @ wk
        v = x @ wv
        scores = torch.einsum("bhqd,bkd->bhqk", q, k) * (Dh ** -0.5)
        p = _softmax(scores, axis=-1)
        o = torch.einsum("bhqk,bkd->bhqd", p, v)
        return (lambda x, *d: x.permute(*d))(o, 0, 2, 1, 3).reshape(B, S, H * Dh) @ wo

    def _B_ref(x, w1, b1, w2, b2):
        y = _layernorm(x, axis=-1)
        h = _gelu(torch.einsum("bsd,df->bsf", y, w1) + b1)
        return torch.einsum("bsf,fd->bsd", h, w2) + b2

    x = A_x
    xn = _layernorm(x, axis=-1)
    return x + _A_ref(xn, A_wq, A_wk, A_wv, A_wo) + _B_ref(xn, B_w1, B_b1, B_w2, B_b2)
```

```asm
; @launch kernel=k1_kernel grid=(176,1,1) block=(512,1,1) lds=108800
; @launch kernel=k2_kernel grid=(512,1,1) block=(256,1,1) lds=81920
; @launch kernel=k3_kernel grid=(256,1,1) block=(512,1,1) lds=153600
; @launch kernel=k4_kernel grid=(576,1,1) block=(256,1,1) lds=0
.amdgcn_target "amdgcn-amd-amdhsa--gfx950"
.text
.globl k1_kernel
.p2align 8
.type k1_kernel,@function
k1_kernel:
    s_cmp_ge_u32 s2, 0xb0
    s_cbranch_scc1 k1_end_1
    s_load_dwordx8 s[4:11], s[0:1], 0
    s_load_dwordx2 s[12:13], s[0:1], 0x60
    v_lshrrev_b32 v1, 6, v0
    s_nop 0
    v_readfirstlane_b32 s28, v1
    v_and_b32 v1, 63, v0
    s_waitcnt lgkmcnt(0)
    s_mov_b32 s20, s12
    s_and_b32 s21, s13, 0xffff
    s_mov_b32 s22, 0x10000000
    s_mov_b32 s23, 0x20000
    s_cmp_ge_u32 s2, 0x80
    s_cbranch_scc1 k1_pack_2
    s_mov_b32 s16, s4
    s_and_b32 s17, s5, 0xffff
    s_mov_b32 s18, 0x240000
    s_mov_b32 s19, 0x20000
    s_cmp_ge_u32 s28, 4
    s_cselect_b32 s14, s10, s8
    s_cselect_b32 s15, s11, s9
    s_mov_b32 s24, s14
    s_and_b32 s25, s15, 0xffff
    s_mov_b32 s26, 0x5100
    s_mov_b32 s27, 0x20000
    v_and_b32 v2, 15, v0
    v_and_b32 v24, 31, v0
    v_lshrrev_b32 v3, 5, v0
    s_lshl_b32 s29, s2, 4
    v_add_u32 v4, s29, v3
    v_mul_u32_u24 v5, 0x480, v4
    v_lshl_add_u32 v5, v24, 2, v5
    buffer_load_dword v28, v5, s[16:19], 0 offen offset:0
    buffer_load_dword v29, v5, s[16:19], 0 offen offset:128
    buffer_load_dword v30, v5, s[16:19], 0 offen offset:256
    buffer_load_dword v31, v5, s[16:19], 0 offen offset:384
    buffer_load_dword v32, v5, s[16:19], 0 offen offset:512
    buffer_load_dword v33, v5, s[16:19], 0 offen offset:640
    buffer_load_dword v34, v5, s[16:19], 0 offen offset:768
    buffer_load_dword v35, v5, s[16:19], 0 offen offset:896
    buffer_load_dword v36, v5, s[16:19], 0 offen offset:1024
    v_lshrrev_b32 v6, 4, v1
    s_lshr_b32 s41, s28, 2
    s_mul_i32 s41, s41, 0xb000
    s_bfe_u32 s42, s28, 0x10001
    s_mul_i32 s42, s42, 0x5804
    s_add_u32 s41, s41, s42
    s_and_b32 s40, s28, 1
    s_mul_i32 s40, s40, 0x2800
    s_add_u32 s41, s41, s40
    s_add_u32 s41, s41, 0x4900
    v_lshlrev_b32 v9, 4, v1
    s_add_u32 m0, s41, 0
    s_add_u32 s42, s40, 0
    buffer_load_dwordx4 v9, s[24:27], s42 offen offset:0 lds
    buffer_load_dwordx4 v9, s[24:27], s42 offen offset:1024 lds
    buffer_load_dwordx4 v9, s[24:27], s42 offen offset:2048 lds
    buffer_load_dwordx4 v9, s[24:27], s42 offen offset:3072 lds
    s_add_u32 m0, s41, 0x1000
    s_add_u32 s42, s40, 0x1000
    buffer_load_dwordx4 v9, s[24:27], s42 offen offset:0 lds
    buffer_load_dwordx4 v9, s[24:27], s42 offen offset:1024 lds
    buffer_load_dwordx4 v9, s[24:27], s42 offen offset:2048 lds
    buffer_load_dwordx4 v9, s[24:27], s42 offen offset:3072 lds
    s_add_u32 m0, s41, 0x2000
    s_add_u32 s42, s40, 0x2000
    buffer_load_dwordx4 v9, s[24:27], s42 offen offset:0 lds
    buffer_load_dwordx4 v9, s[24:27], s42 offen offset:1024 lds
    buffer_load_dwordx4 v9, s[24:27], s42 offen offset:2048 lds
    s_and_b32 s30, s28, 1
    s_bfe_u32 s31, s28, 0x10001
    s_mul_i32 s31, s31, 0xb000
    s_add_u32 s31, s31, 0x4900
    s_lshl_b32 s30, s30, 4
    v_lshrrev_b32 v8, 2, v2
    v_lshl_add_u32 v7, v6, 3, v8
    v_mul_u32_u24 v7, 36, v7
    v_and_b32 v8, 1, v8
    v_mul_u32_u24 v8, 0x5804, v8
    v_add_u32 v7, v7, v8
    v_and_b32 v8, 3, v2
    v_lshl_add_u32 v7, v8, 3, v7
    s_lshl_b32 s43, s30, 1
    s_add_u32 s43, s43, s31
    v_add_u32 v7, s43, v7
    s_waitcnt vmcnt(11)
    v_lshlrev_b32 v48, 16, v28
    v_and_b32 v49, 0xffff0000, v28
    v_lshlrev_b32 v50, 16, v29
    v_and_b32 v51, 0xffff0000, v29
    v_lshlrev_b32 v52, 16, v30
    v_and_b32 v53, 0xffff0000, v30
    v_lshlrev_b32 v54, 16, v31
    v_and_b32 v55, 0xffff0000, v31
    v_lshlrev_b32 v56, 16, v32
    v_and_b32 v57, 0xffff0000, v32
    v_lshlrev_b32 v58, 16, v33
    v_and_b32 v59, 0xffff0000, v33
    v_lshlrev_b32 v60, 16, v34
    v_and_b32 v61, 0xffff0000, v34
    v_lshlrev_b32 v62, 16, v35
    v_and_b32 v63, 0xffff0000, v35
    v_lshlrev_b32 v64, 16, v36
    v_and_b32 v65, 0xffff0000, v36
    v_add_f32 v10, v48, v49
    v_add_f32 v10, v10, v50
    v_add_f32 v10, v10, v51
    v_add_f32 v10, v10, v52
    v_add_f32 v10, v10, v53
    v_add_f32 v10, v10, v54
    v_add_f32 v10, v10, v55
    v_add_f32 v10, v10, v56
    v_add_f32 v10, v10, v57
    v_add_f32 v10, v10, v58
    v_add_f32 v10, v10, v59
    v_add_f32 v10, v10, v60
    v_add_f32 v10, v10, v61
    v_add_f32 v10, v10, v62
    v_add_f32 v10, v10, v63
    v_add_f32 v10, v10, v64
    v_add_f32 v10, v10, v65
    s_nop 1
    v_add_f32_dpp v11, v10, v10 row_ror:8 row_mask:0xf bank_mask:0xf
    v_mov_b32 v10, v11
    s_nop 1
    v_add_f32_dpp v11, v10, v10 row_ror:4 row_mask:0xf bank_mask:0xf
    v_mov_b32 v10, v11
    s_nop 1
    v_add_f32_dpp v11, v10, v10 row_ror:2 row_mask:0xf bank_mask:0xf
    v_mov_b32 v10, v11
    s_nop 1
    v_add_f32_dpp v11, v10, v10 row_ror:1 row_mask:0xf bank_mask:0xf
    v_mov_b32 v10, v11
    v_mov_b32 v16, v10
    s_nop 1
    v_permlane16_swap_b32 v11, v16
    v_add_f32 v10, v11, v16
    v_mul_f32 v12, 0x3ae38e39, v10
    v_mov_b32 v13, 0
    v_sub_f32 v11, v48, v12
    v_fmac_f32 v13, v11, v11
    v_sub_f32 v11, v49, v12
    v_fmac_f32 v13, v11, v11
    v_sub_f32 v11, v50, v12
    v_fmac_f32 v13, v11, v11
    v_sub_f32 v11, v51, v12
    v_fmac_f32 v13, v11, v11
    v_sub_f32 v11, v52, v12
    v_fmac_f32 v13, v11, v11
    v_sub_f32 v11, v53, v12
    v_fmac_f32 v13, v11, v11
    v_sub_f32 v11, v54, v12
    v_fmac_f32 v13, v11, v11
    v_sub_f32 v11, v55, v12
    v_fmac_f32 v13, v11, v11
    v_sub_f32 v11, v56, v12
    v_fmac_f32 v13, v11, v11
    v_sub_f32 v11, v57, v12
    v_fmac_f32 v13, v11, v11
    v_sub_f32 v11, v58, v12
    v_fmac_f32 v13, v11, v11
    v_sub_f32 v11, v59, v12
    v_fmac_f32 v13, v11, v11
    v_sub_f32 v11, v60, v12
    v_fmac_f32 v13, v11, v11
    v_sub_f32 v11, v61, v12
    v_fmac_f32 v13, v11, v11
    v_sub_f32 v11, v62, v12
    v_fmac_f32 v13, v11, v11
    v_sub_f32 v11, v63, v12
    v_fmac_f32 v13, v11, v11
    v_sub_f32 v11, v64, v12
    v_fmac_f32 v13, v11, v11
    v_sub_f32 v11, v65, v12
    v_fmac_f32 v13, v11, v11
    s_nop 1
    v_add_f32_dpp v11, v13, v13 row_ror:8 row_mask:0xf bank_mask:0xf
    v_mov_b32 v13, v11
    s_nop 1
    v_add_f32_dpp v11, v13, v13 row_ror:4 row_mask:0xf bank_mask:0xf
    v_mov_b32 v13, v11
    s_nop 1
    v_add_f32_dpp v11, v13, v13 row_ror:2 row_mask:0xf bank_mask:0xf
    v_mov_b32 v13, v11
    s_nop 1
    v_add_f32_dpp v11, v13, v13 row_ror:1 row_mask:0xf bank_mask:0xf
    v_mov_b32 v13, v11
    v_mov_b32 v16, v13
    s_nop 1
    v_permlane16_swap_b32 v11, v16
    v_add_f32 v13, v11, v16
    v_mul_f32 v13, 0x3ae38e39, v13
    v_cvt_pk_bf16_f32 v11, v12, v13
    v_lshlrev_b32 v14, 16, v11
    v_and_b32 v13, 0xffff0000, v11
    v_add_f32 v13, 0x3727c5ac, v13
    v_cvt_pk_bf16_f32 v11, v13, v13
    v_lshlrev_b32 v13, 16, v11
    v_sqrt_f32 v13, v13
    s_nop 0
    v_cvt_pk_bf16_f32 v11, v13, v13
    v_lshlrev_b32 v13, 16, v11
    v_rcp_f32 v15, v13
    v_sub_f32 v48, v48, v14
    v_sub_f32 v49, v49, v14
    v_cvt_pk_bf16_f32 v11, v48, v49
    v_lshlrev_b32 v48, 16, v11
    v_and_b32 v49, 0xffff0000, v11
    v_mul_f32 v48, v48, v15
    v_mul_f32 v49, v49, v15
    v_cvt_pk_bf16_f32 v28, v48, v49
    v_sub_f32 v50, v50, v14
    v_sub_f32 v51, v51, v14
    v_cvt_pk_bf16_f32 v11, v50, v51
    v_lshlrev_b32 v50, 16, v11
    v_and_b32 v51, 0xffff0000, v11
    v_mul_f32 v50, v50, v15
    v_mul_f32 v51, v51, v15
    v_cvt_pk_bf16_f32 v29, v50, v51
    v_sub_f32 v52, v52, v14
    v_sub_f32 v53, v53, v14
    v_cvt_pk_bf16_f32 v11, v52, v53
    v_lshlrev_b32 v52, 16, v11
    v_and_b32 v53, 0xffff0000, v11
    v_mul_f32 v52, v52, v15
    v_mul_f32 v53, v53, v15
    v_cvt_pk_bf16_f32 v30, v52, v53
    v_sub_f32 v54, v54, v14
    v_sub_f32 v55, v55, v14
    v_cvt_pk_bf16_f32 v11, v54, v55
    v_lshlrev_b32 v54, 16, v11
    v_and_b32 v55, 0xffff0000, v11
    v_mul_f32 v54, v54, v15
    v_mul_f32 v55, v55, v15
    v_cvt_pk_bf16_f32 v31, v54, v55
    v_sub_f32 v56, v56, v14
    v_sub_f32 v57, v57, v14
    v_cvt_pk_bf16_f32 v11, v56, v57
    v_lshlrev_b32 v56, 16, v11
    v_and_b32 v57, 0xffff0000, v11
    v_mul_f32 v56, v56, v15
    v_mul_f32 v57, v57, v15
    v_cvt_pk_bf16_f32 v32, v56, v57
    v_sub_f32 v58, v58, v14
    v_sub_f32 v59, v59, v14
    v_cvt_pk_bf16_f32 v11, v58, v59
    v_lshlrev_b32 v58, 16, v11
    v_and_b32 v59, 0xffff0000, v11
    v_mul_f32 v58, v58, v15
    v_mul_f32 v59, v59, v15
    v_cvt_pk_bf16_f32 v33, v58, v59
    v_sub_f32 v60, v60, v14
    v_sub_f32 v61, v61, v14
    v_cvt_pk_bf16_f32 v11, v60, v61
    v_lshlrev_b32 v60, 16, v11
    v_and_b32 v61, 0xffff0000, v11
    v_mul_f32 v60, v60, v15
    v_mul_f32 v61, v61, v15
    v_cvt_pk_bf16_f32 v34, v60, v61
    v_sub_f32 v62, v62, v14
    v_sub_f32 v63, v63, v14
    v_cvt_pk_bf16_f32 v11, v62, v63
    v_lshlrev_b32 v62, 16, v11
    v_and_b32 v63, 0xffff0000, v11
    v_mul_f32 v62, v62, v15
    v_mul_f32 v63, v63, v15
    v_cvt_pk_bf16_f32 v35, v62, v63
    v_sub_f32 v64, v64, v14
    v_sub_f32 v65, v65, v14
    v_cvt_pk_bf16_f32 v11, v64, v65
    v_lshlrev_b32 v64, 16, v11
    v_and_b32 v65, 0xffff0000, v11
    v_mul_f32 v64, v64, v15
    v_mul_f32 v65, v65, v15
    v_cvt_pk_bf16_f32 v36, v64, v65
    s_mov_b32 s48, 0
    s_mov_b32 s49, 0x1000
    s_mov_b32 s50, 0x2000
    s_mov_b32 s51, 0x3000
    s_mov_b32 s52, 0x4000
    s_mov_b32 s53, 0x5000
    s_mov_b32 s54, 0x6000
    s_mov_b32 s55, 0x7000
    s_mov_b32 s56, 0x8000
    v_lshrrev_b32 v18, 5, v4
    v_mul_u32_u24 v18, 0x9000, v18
    v_lshrrev_b32 v19, 3, v24
    v_lshl_add_u32 v18, v19, 10, v18
    v_bfe_u32 v19, v24, 2, 1
    v_lshlrev_b32 v19, 5, v19
    v_and_b32 v20, 31, v4
    v_add_u32 v19, v19, v20
    v_lshl_add_u32 v18, v19, 4, v18
    v_and_b32 v19, 3, v24
    v_lshl_add_u32 v18, v19, 2, v18
    buffer_store_dword v28, v18, s[20:23], s48 offen
    buffer_store_dword v29, v18, s[20:23], s49 offen
    buffer_store_dword v30, v18, s[20:23], s50 offen
    buffer_store_dword v31, v18, s[20:23], s51 offen
    buffer_store_dword v32, v18, s[20:23], s52 offen
    buffer_store_dword v33, v18, s[20:23], s53 offen
    buffer_store_dword v34, v18, s[20:23], s54 offen
    buffer_store_dword v35, v18, s[20:23], s55 offen
    buffer_store_dword v36, v18, s[20:23], s56 offen
    v_mul_u32_u24 v21, 0x490, v3
    v_lshl_add_u32 v21, v24, 2, v21
    ds_write_b32 v21, v28 offset:0
    ds_write_b32 v21, v29 offset:128
    ds_write_b32 v21, v30 offset:256
    ds_write_b32 v21, v31 offset:384
    ds_write_b32 v21, v32 offset:512
    ds_write_b32 v21, v33 offset:640
    ds_write_b32 v21, v34 offset:768
    ds_write_b32 v21, v35 offset:896
    ds_write_b32 v21, v36 offset:1024
    v_lshlrev_b32 v48, 16, v28
    v_and_b32 v49, 0xffff0000, v28
    v_lshlrev_b32 v50, 16, v29
    v_and_b32 v51, 0xffff0000, v29
    v_lshlrev_b32 v52, 16, v30
    v_and_b32 v53, 0xffff0000, v30
    v_lshlrev_b32 v54, 16, v31
    v_and_b32 v55, 0xffff0000, v31
    v_lshlrev_b32 v56, 16, v32
    v_and_b32 v57, 0xffff0000, v32
    v_lshlrev_b32 v58, 16, v33
    v_and_b32 v59, 0xffff0000, v33
    v_lshlrev_b32 v60, 16, v34
    v_and_b32 v61, 0xffff0000, v34
    v_lshlrev_b32 v62, 16, v35
    v_and_b32 v63, 0xffff0000, v35
    v_lshlrev_b32 v64, 16, v36
    v_and_b32 v65, 0xffff0000, v36
    v_add_f32 v10, v48, v49
    v_add_f32 v10, v10, v50
    v_add_f32 v10, v10, v51
    v_add_f32 v10, v10, v52
    v_add_f32 v10, v10, v53
    v_add_f32 v10, v10, v54
    v_add_f32 v10, v10, v55
    v_add_f32 v10, v10, v56
    v_add_f32 v10, v10, v57
    v_add_f32 v10, v10, v58
    v_add_f32 v10, v10, v59
    v_add_f32 v10, v10, v60
    v_add_f32 v10, v10, v61
    v_add_f32 v10, v10, v62
    v_add_f32 v10, v10, v63
    v_add_f32 v10, v10, v64
    v_add_f32 v10, v10, v65
    s_nop 1
    v_add_f32_dpp v11, v10, v10 row_ror:8 row_mask:0xf bank_mask:0xf
    v_mov_b32 v10, v11
    s_nop 1
    v_add_f32_dpp v11, v10, v10 row_ror:4 row_mask:0xf bank_mask:0xf
    v_mov_b32 v10, v11
    s_nop 1
    v_add_f32_dpp v11, v10, v10 row_ror:2 row_mask:0xf bank_mask:0xf
    v_mov_b32 v10, v11
    s_nop 1
    v_add_f32_dpp v11, v10, v10 row_ror:1 row_mask:0xf bank_mask:0xf
    v_mov_b32 v10, v11
    v_mov_b32 v16, v10
    s_nop 1
    v_permlane16_swap_b32 v11, v16
    v_add_f32 v10, v11, v16
    v_mul_f32 v12, 0x3ae38e39, v10
    v_mov_b32 v13, 0
    v_sub_f32 v11, v48, v12
    v_fmac_f32 v13, v11, v11
    v_sub_f32 v11, v49, v12
    v_fmac_f32 v13, v11, v11
    v_sub_f32 v11, v50, v12
    v_fmac_f32 v13, v11, v11
    v_sub_f32 v11, v51, v12
    v_fmac_f32 v13, v11, v11
    v_sub_f32 v11, v52, v12
    v_fmac_f32 v13, v11, v11
    v_sub_f32 v11, v53, v12
    v_fmac_f32 v13, v11, v11
    v_sub_f32 v11, v54, v12
    v_fmac_f32 v13, v11, v11
    v_sub_f32 v11, v55, v12
    v_fmac_f32 v13, v11, v11
    v_sub_f32 v11, v56, v12
    v_fmac_f32 v13, v11, v11
    v_sub_f32 v11, v57, v12
    v_fmac_f32 v13, v11, v11
    v_sub_f32 v11, v58, v12
    v_fmac_f32 v13, v11, v11
    v_sub_f32 v11, v59, v12
    v_fmac_f32 v13, v11, v11
    v_sub_f32 v11, v60, v12
    v_fmac_f32 v13, v11, v11
    v_sub_f32 v11, v61, v12
    v_fmac_f32 v13, v11, v11
    v_sub_f32 v11, v62, v12
    v_fmac_f32 v13, v11, v11
    v_sub_f32 v11, v63, v12
    v_fmac_f32 v13, v11, v11
    v_sub_f32 v11, v64, v12
    v_fmac_f32 v13, v11, v11
    v_sub_f32 v11, v65, v12
    v_fmac_f32 v13, v11, v11
    s_nop 1
    v_add_f32_dpp v11, v13, v13 row_ror:8 row_mask:0xf bank_mask:0xf
    v_mov_b32 v13, v11
    s_nop 1
    v_add_f32_dpp v11, v13, v13 row_ror:4 row_mask:0xf bank_mask:0xf
    v_mov_b32 v13, v11
    s_nop 1
    v_add_f32_dpp v11, v13, v13 row_ror:2 row_mask:0xf bank_mask:0xf
    v_mov_b32 v13, v11
    s_nop 1
    v_add_f32_dpp v11, v13, v13 row_ror:1 row_mask:0xf bank_mask:0xf
    v_mov_b32 v13, v11
    v_mov_b32 v16, v13
    s_nop 1
    v_permlane16_swap_b32 v11, v16
    v_add_f32 v13, v11, v16
    v_mul_f32 v13, 0x3ae38e39, v13
    v_cvt_pk_bf16_f32 v11, v12, v13
    v_lshlrev_b32 v14, 16, v11
    v_and_b32 v13, 0xffff0000, v11
    v_add_f32 v13, 0x3727c5ac, v13
    v_cvt_pk_bf16_f32 v11, v13, v13
    v_lshlrev_b32 v13, 16, v11
    v_sqrt_f32 v13, v13
    s_nop 0
    v_cvt_pk_bf16_f32 v11, v13, v13
    v_lshlrev_b32 v13, 16, v11
    v_rcp_f32 v15, v13
    v_sub_f32 v48, v48, v14
    v_sub_f32 v49, v49, v14
    v_cvt_pk_bf16_f32 v11, v48, v49
    v_lshlrev_b32 v48, 16, v11
    v_and_b32 v49, 0xffff0000, v11
    v_mul_f32 v48, v48, v15
    v_mul_f32 v49, v49, v15
    v_cvt_pk_bf16_f32 v84, v48, v49
    v_sub_f32 v50, v50, v14
    v_sub_f32 v51, v51, v14
    v_cvt_pk_bf16_f32 v11, v50, v51
    v_lshlrev_b32 v50, 16, v11
    v_and_b32 v51, 0xffff0000, v11
    v_mul_f32 v50, v50, v15
    v_mul_f32 v51, v51, v15
    v_cvt_pk_bf16_f32 v85, v50, v51
    v_sub_f32 v52, v52, v14
    v_sub_f32 v53, v53, v14
    v_cvt_pk_bf16_f32 v11, v52, v53
    v_lshlrev_b32 v52, 16, v11
    v_and_b32 v53, 0xffff0000, v11
    v_mul_f32 v52, v52, v15
    v_mul_f32 v53, v53, v15
    v_cvt_pk_bf16_f32 v86, v52, v53
    v_sub_f32 v54, v54, v14
    v_sub_f32 v55, v55, v14
    v_cvt_pk_bf16_f32 v11, v54, v55
    v_lshlrev_b32 v54, 16, v11
    v_and_b32 v55, 0xffff0000, v11
    v_mul_f32 v54, v54, v15
    v_mul_f32 v55, v55, v15
    v_cvt_pk_bf16_f32 v87, v54, v55
    v_sub_f32 v56, v56, v14
    v_sub_f32 v57, v57, v14
    v_cvt_pk_bf16_f32 v11, v56, v57
    v_lshlrev_b32 v56, 16, v11
    v_and_b32 v57, 0xffff0000, v11
    v_mul_f32 v56, v56, v15
    v_mul_f32 v57, v57, v15
    v_cvt_pk_bf16_f32 v88, v56, v57
    v_sub_f32 v58, v58, v14
    v_sub_f32 v59, v59, v14
    v_cvt_pk_bf16_f32 v11, v58, v59
    v_lshlrev_b32 v58, 16, v11
    v_and_b32 v59, 0xffff0000, v11
    v_mul_f32 v58, v58, v15
    v_mul_f32 v59, v59, v15
    v_cvt_pk_bf16_f32 v89, v58, v59
    v_sub_f32 v60, v60, v14
    v_sub_f32 v61, v61, v14
    v_cvt_pk_bf16_f32 v11, v60, v61
    v_lshlrev_b32 v60, 16, v11
    v_and_b32 v61, 0xffff0000, v11
    v_mul_f32 v60, v60, v15
    v_mul_f32 v61, v61, v15
    v_cvt_pk_bf16_f32 v90, v60, v61
    v_sub_f32 v62, v62, v14
    v_sub_f32 v63, v63, v14
    v_cvt_pk_bf16_f32 v11, v62, v63
    v_lshlrev_b32 v62, 16, v11
    v_and_b32 v63, 0xffff0000, v11
    v_mul_f32 v62, v62, v15
    v_mul_f32 v63, v63, v15
    v_cvt_pk_bf16_f32 v91, v62, v63
    v_sub_f32 v64, v64, v14
    v_sub_f32 v65, v65, v14
    v_cvt_pk_bf16_f32 v11, v64, v65
    v_lshlrev_b32 v64, 16, v11
    v_and_b32 v65, 0xffff0000, v11
    v_mul_f32 v64, v64, v15
    v_mul_f32 v65, v65, v15
    v_cvt_pk_bf16_f32 v92, v64, v65
    v_lshrrev_b32 v18, 4, v4
    v_mul_u32_u24 v18, 0x4800, v18
    v_lshrrev_b32 v19, 2, v24
    v_lshl_add_u32 v18, v19, 8, v18
    v_and_b32 v19, 15, v4
    v_lshl_add_u32 v18, v19, 4, v18
    v_and_b32 v19, 3, v24
    v_lshl_add_u32 v18, v19, 2, v18
    s_mov_b32 s64, 0x240000
    s_mov_b32 s65, 0x241000
    s_mov_b32 s66, 0x242000
    s_mov_b32 s67, 0x243000
    s_mov_b32 s68, 0x244000
    buffer_store_dword v84, v18, s[20:23], s64 offen offset:0
    buffer_store_dword v85, v18, s[20:23], s64 offen offset:2048
    buffer_store_dword v86, v18, s[20:23], s65 offen offset:0
    buffer_store_dword v87, v18, s[20:23], s65 offen offset:2048
    buffer_store_dword v88, v18, s[20:23], s66 offen offset:0
    buffer_store_dword v89, v18, s[20:23], s66 offen offset:2048
    buffer_store_dword v90, v18, s[20:23], s67 offen offset:0
    buffer_store_dword v91, v18, s[20:23], s67 offen offset:2048
    buffer_store_dword v92, v18, s[20:23], s68 offen offset:0
    s_waitcnt vmcnt(18) lgkmcnt(0)
    s_barrier
    s_cmp_lt_u32 s28, 4
    s_cbranch_scc1 k1_kv_3
    s_lshl_b32 s74, s2, 2
    s_add_u32 s74, s74, s28
    s_sub_u32 s74, s74, 4
    s_lshl_b32 s74, s74, 1
    s_load_dwordx2 s[68:69], s[0:1], 48
    s_load_dwordx2 s[70:71], s[0:1], 64
    s_load_dwordx2 s[72:73], s[0:1], 32
    v_lshlrev_b32 v250, 7, v1
    s_waitcnt lgkmcnt(0)
    s_add_u32 s75, s74, 0
    s_sub_u32 s96, s75, 0x288
    s_sub_u32 s97, s75, 0x510
    s_cmp_lt_u32 s75, 0x510
    s_cselect_b32 s98, s70, s72
    s_cselect_b32 s99, s71, s73
    s_cselect_b32 s100, s96, s97
    s_cmp_lt_u32 s75, 0x288
    s_cselect_b32 s98, s68, s98
    s_cselect_b32 s99, s69, s99
    s_cselect_b32 s100, s75, s100
    s_mov_b32 s101, 0x510000
    s_cmp_lt_u32 s75, 0x510
    s_cselect_b32 s101, s101, 0xa2000
    s_mov_b32 s76, s98
    s_and_b32 s77, s99, 0xffff
    s_mov_b32 s78, s101
    s_mov_b32 s79, 0x20000
    s_lshl_b32 s100, s100, 13
    buffer_load_dword v251, v250, s[76:79], s100 offen
    s_add_u32 s75, s74, 1
    s_sub_u32 s96, s75, 0x288
    s_sub_u32 s97, s75, 0x510
    s_cmp_lt_u32 s75, 0x510
    s_cselect_b32 s98, s70, s72
    s_cselect_b32 s99, s71, s73
    s_cselect_b32 s100, s96, s97
    s_cmp_lt_u32 s75, 0x288
    s_cselect_b32 s98, s68, s98
    s_cselect_b32 s99, s69, s99
    s_cselect_b32 s100, s75, s100
    s_mov_b32 s101, 0x510000
    s_cmp_lt_u32 s75, 0x510
    s_cselect_b32 s101, s101, 0xa2000
    s_mov_b32 s76, s98
    s_and_b32 s77, s99, 0xffff
    s_mov_b32 s78, s101
    s_mov_b32 s79, 0x20000
    s_lshl_b32 s100, s100, 13
    buffer_load_dword v252, v250, s[76:79], s100 offen
    s_endpgm
k1_kv_3:
    ds_read_b64_tr_b16 v[100:101], v7 offset:0
    ds_read_b64_tr_b16 v[102:103], v7 offset:144
    ds_read_b64_tr_b16 v[108:109], v7 offset:1152
    ds_read_b64_tr_b16 v[110:111], v7 offset:1296
    ds_read_b64_tr_b16 v[116:117], v7 offset:2304
    ds_read_b64_tr_b16 v[118:119], v7 offset:2448
    ds_read_b64_tr_b16 v[124:125], v7 offset:3456
    ds_read_b64_tr_b16 v[126:127], v7 offset:3600
    ds_read_b64_tr_b16 v[132:133], v7 offset:4608
    ds_read_b64_tr_b16 v[134:135], v7 offset:4752
    ds_read_b64_tr_b16 v[140:141], v7 offset:5760
    ds_read_b64_tr_b16 v[142:143], v7 offset:5904
    ds_read_b64_tr_b16 v[148:149], v7 offset:6912
    ds_read_b64_tr_b16 v[150:151], v7 offset:7056
    ds_read_b64_tr_b16 v[156:157], v7 offset:8064
    ds_read_b64_tr_b16 v[158:159], v7 offset:8208
    ds_read_b64_tr_b16 v[164:165], v7 offset:9216
    ds_read_b64_tr_b16 v[166:167], v7 offset:9360
    ds_read_b64_tr_b16 v[172:173], v7 offset:10368
    ds_read_b64_tr_b16 v[174:175], v7 offset:10512
    ds_read_b64_tr_b16 v[180:181], v7 offset:11520
    ds_read_b64_tr_b16 v[182:183], v7 offset:11664
    ds_read_b64_tr_b16 v[188:189], v7 offset:12672
    ds_read_b64_tr_b16 v[190:191], v7 offset:12816
    ds_read_b64_tr_b16 v[196:197], v7 offset:13824
    ds_read_b64_tr_b16 v[198:199], v7 offset:13968
    ds_read_b64_tr_b16 v[204:205], v7 offset:14976
    ds_read_b64_tr_b16 v[206:207], v7 offset:15120
    ds_read_b64_tr_b16 v[212:213], v7 offset:16128
    ds_read_b64_tr_b16 v[214:215], v7 offset:16272
    ds_read_b64_tr_b16 v[220:221], v7 offset:17280
    ds_read_b64_tr_b16 v[222:223], v7 offset:17424
    ds_read_b64_tr_b16 v[228:229], v7 offset:18432
    ds_read_b64_tr_b16 v[230:231], v7 offset:18576
    ds_read_b64_tr_b16 v[236:237], v7 offset:19584
    ds_read_b64_tr_b16 v[238:239], v7 offset:19728
    v_mul_u32_u24 v21, 0x490, v2
    v_lshl_add_u32 v21, v6, 4, v21
    ds_read_b128 v[28:31], v21 offset:0
    ds_read_b128 v[32:35], v21 offset:64
    ds_read_b128 v[36:39], v21 offset:128
    ds_read_b128 v[40:43], v21 offset:192
    ds_read_b128 v[44:47], v21 offset:256
    ds_read_b128 v[48:51], v21 offset:320
    ds_read_b128 v[52:55], v21 offset:384
    ds_read_b128 v[56:59], v21 offset:448
    ds_read_b128 v[60:63], v21 offset:512
    ds_read_b128 v[64:67], v21 offset:576
    ds_read_b128 v[68:71], v21 offset:640
    ds_read_b128 v[72:75], v21 offset:704
    ds_read_b128 v[76:79], v21 offset:768
    ds_read_b128 v[80:83], v21 offset:832
    ds_read_b128 v[84:87], v21 offset:896
    ds_read_b128 v[88:91], v21 offset:960
    ds_read_b128 v[92:95], v21 offset:1024
    ds_read_b128 v[96:99], v21 offset:1088
    v_mov_b32 v12, 0
    v_mov_b32 v13, 0
    v_mov_b32 v14, 0
    v_mov_b32 v15, 0
    s_waitcnt lgkmcnt(0)
    s_lshr_b32 s58, s2, 1
    s_lshl_b32 s58, s58, 12
    s_add_u32 s58, s58, 0x480000
    s_and_b32 s59, s2, 1
    s_cmp_ge_u32 s28, 2
    s_cbranch_scc1 k1_v_4
    v_mfma_f32_16x16x32_bf16 v[12:15], v[100:103], v[28:31], v[12:15]
    v_mfma_f32_16x16x32_bf16 v[12:15], v[108:111], v[32:35], v[12:15]
    v_mfma_f32_16x16x32_bf16 v[12:15], v[116:119], v[36:39], v[12:15]
    v_mfma_f32_16x16x32_bf16 v[12:15], v[124:127], v[40:43], v[12:15]
    v_mfma_f32_16x16x32_bf16 v[12:15], v[132:135], v[44:47], v[12:15]
    v_mfma_f32_16x16x32_bf16 v[12:15], v[140:143], v[48:51], v[12:15]
    v_mfma_f32_16x16x32_bf16 v[12:15], v[148:151], v[52:55], v[12:15]
    v_mfma_f32_16x16x32_bf16 v[12:15], v[156:159], v[56:59], v[12:15]
    v_mfma_f32_16x16x32_bf16 v[12:15], v[164:167], v[60:63], v[12:15]
    v_mfma_f32_16x16x32_bf16 v[12:15], v[172:175], v[64:67], v[12:15]
    v_mfma_f32_16x16x32_bf16 v[12:15], v[180:183], v[68:71], v[12:15]
    v_mfma_f32_16x16x32_bf16 v[12:15], v[188:191], v[72:75], v[12:15]
    v_mfma_f32_16x16x32_bf16 v[12:15], v[196:199], v[76:79], v[12:15]
    v_mfma_f32_16x16x32_bf16 v[12:15], v[204:207], v[80:83], v[12:15]
    v_mfma_f32_16x16x32_bf16 v[12:15], v[212:215], v[84:87], v[12:15]
    v_mfma_f32_16x16x32_bf16 v[12:15], v[220:223], v[88:91], v[12:15]
    v_mfma_f32_16x16x32_bf16 v[12:15], v[228:231], v[92:95], v[12:15]
    v_mfma_f32_16x16x32_bf16 v[12:15], v[236:239], v[96:99], v[12:15]
    s_lshl_b32 s60, s30, 6
    s_add_u32 s58, s58, s60
    s_lshl_b32 s60, s59, 8
    s_add_u32 s58, s58, s60
    v_lshrrev_b32 v18, 1, v6
    v_lshlrev_b32 v18, 5, v18
    v_add_u32 v18, v18, v2
    v_lshlrev_b32 v18, 4, v18
    v_and_b32 v19, 1, v6
    v_lshl_add_u32 v18, v19, 3, v18
    v_cmp_eq_u32 vcc, 0, v6
    s_cmp_eq_u32 s28, 1
    s_cselect_b64 s[62:63], vcc, 0
    s_cselect_b64 s[64:65], -1, 0
    s_andn2_b64 s[66:67], s[64:65], s[62:63]
    v_cndmask_b32 v12, v12, 0, s[66:67]
    v_cndmask_b32 v13, v13, 0, s[66:67]
    v_cndmask_b32 v14, v14, 0, s[64:65]
    v_cndmask_b32 v15, v15, 0, s[64:65]
    v_cndmask_b32 v14, v14, 1.0, s[62:63]
    v_cvt_pk_bf16_f32 v16, v12, v13
    v_cvt_pk_bf16_f32 v17, v14, v15
    buffer_store_dwordx2 v[16:17], v18, s[20:23], s58 offen
    s_waitcnt vmcnt(0) lgkmcnt(0)
    s_waitcnt lgkmcnt(0)
    s_endpgm
k1_v_4:
    v_mfma_f32_16x16x32_bf16 v[12:15], v[28:31], v[100:103], v[12:15]
    v_mfma_f32_16x16x32_bf16 v[12:15], v[32:35], v[108:111], v[12:15]
    v_mfma_f32_16x16x32_bf16 v[12:15], v[36:39], v[116:119], v[12:15]
    v_mfma_f32_16x16x32_bf16 v[12:15], v[40:43], v[124:127], v[12:15]
    v_mfma_f32_16x16x32_bf16 v[12:15], v[44:47], v[132:135], v[12:15]
    v_mfma_f32_16x16x32_bf16 v[12:15], v[48:51], v[140:143], v[12:15]
    v_mfma_f32_16x16x32_bf16 v[12:15], v[52:55], v[148:151], v[12:15]
    v_mfma_f32_16x16x32_bf16 v[12:15], v[56:59], v[156:159], v[12:15]
    v_mfma_f32_16x16x32_bf16 v[12:15], v[60:63], v[164:167], v[12:15]
    v_mfma_f32_16x16x32_bf16 v[12:15], v[64:67], v[172:175], v[12:15]
    v_mfma_f32_16x16x32_bf16 v[12:15], v[68:71], v[180:183], v[12:15]
    v_mfma_f32_16x16x32_bf16 v[12:15], v[72:75], v[188:191], v[12:15]
    v_mfma_f32_16x16x32_bf16 v[12:15], v[76:79], v[196:199], v[12:15]
    v_mfma_f32_16x16x32_bf16 v[12:15], v[80:83], v[204:207], v[12:15]
    v_mfma_f32_16x16x32_bf16 v[12:15], v[84:87], v[212:215], v[12:15]
    v_mfma_f32_16x16x32_bf16 v[12:15], v[88:91], v[220:223], v[12:15]
    v_mfma_f32_16x16x32_bf16 v[12:15], v[92:95], v[228:231], v[12:15]
    v_mfma_f32_16x16x32_bf16 v[12:15], v[96:99], v[236:239], v[12:15]
    s_lshl_b32 s60, s59, 10
    s_add_u32 s58, s58, s60
    s_add_u32 s58, s58, 0x800
    s_lshl_b32 s60, s30, 4
    s_add_u32 s58, s58, s60
    v_and_b32 v18, 1, v6
    v_lshlrev_b32 v18, 5, v18
    v_add_u32 v18, v18, v2
    v_lshlrev_b32 v18, 4, v18
    v_lshrrev_b32 v19, 1, v6
    v_lshl_add_u32 v18, v19, 3, v18
    v_cmp_eq_u32 vcc, 2, v2
    s_cmp_eq_u32 s28, 3
    s_cselect_b64 s[62:63], vcc, 0
    v_cmp_lt_u32 vcc, 2, v2
    s_nop 0
    s_cselect_b64 s[64:65], vcc, 0
    v_cndmask_b32 v12, v12, 1.0, s[62:63]
    v_cndmask_b32 v12, v12, 0, s[64:65]
    v_cndmask_b32 v13, v13, 1.0, s[62:63]
    v_cndmask_b32 v13, v13, 0, s[64:65]
    v_cndmask_b32 v14, v14, 1.0, s[62:63]
    v_cndmask_b32 v14, v14, 0, s[64:65]
    v_cndmask_b32 v15, v15, 1.0, s[62:63]
    v_cndmask_b32 v15, v15, 0, s[64:65]
    v_cvt_pk_bf16_f32 v16, v12, v13
    v_cvt_pk_bf16_f32 v17, v14, v15
    buffer_store_dwordx2 v[16:17], v18, s[20:23], s58 offen
    s_endpgm
k1_pack_2:
    s_mov_b32 s32, s6
    s_and_b32 s33, s7, 0xffff
    s_mov_b32 s34, 0xa2040
    s_mov_b32 s35, 0x20000
    s_sub_u32 s36, s2, 0x80
    s_lshl_b32 s36, s36, 3
    s_add_u32 s36, s36, s28
    s_mul_i32 s37, s36, 0xaaab
    s_lshr_b32 s37, s37, 19
    s_mul_i32 s38, s37, 12
    s_sub_u32 s38, s36, s38
    s_mul_i32 s38, s38, 3
    v_and_b32 v2, 31, v1
    v_bfe_u32 v3, v2, 2, 1
    v_lshrrev_b32 v4, 3, v2
    v_lshlrev_b32 v4, 2, v4
    v_and_b32 v6, 3, v2
    v_or_b32 v4, v4, v6
    v_lshl_add_u32 v5, v3, 3, v4
    v_and_b32 v6, 8, v4
    v_add_u32 v5, v5, v6
    v_lshrrev_b32 v6, 5, v1
    v_mul_u32_u24 v7, 0x2400, v6
    v_lshl_add_u32 v7, v5, 1, v7
    v_mov_b32 v9, 0x7ff00000
    v_cmp_gt_u32 vcc, 18, v5
    s_nop 1
    v_cndmask_b32 v7, v9, v7, vcc
    s_mul_i32 s39, s38, 0x4800
    s_mul_i32 s40, s37, 36
    s_add_u32 s39, s39, s40
    s_add_u32 s41, s39, 0
    s_add_u32 s42, s39, 0xd80
    s_add_u32 s43, s39, 0x1b00
    buffer_load_ushort v16, v7, s[32:35], s41 offen offset:0
    buffer_load_ushort v17, v7, s[32:35], s41 offen offset:1152
    buffer_load_ushort v18, v7, s[32:35], s41 offen offset:2304
    buffer_load_ushort v19, v7, s[32:35], s42 offen offset:0
    buffer_load_ushort v20, v7, s[32:35], s42 offen offset:1152
    buffer_load_ushort v21, v7, s[32:35], s42 offen offset:2304
    buffer_load_ushort v22, v7, s[32:35], s43 offen offset:0
    buffer_load_ushort v23, v7, s[32:35], s43 offen offset:1152
    s_add_u32 s41, s39, 0x4800
    s_add_u32 s42, s39, 0x5580
    s_add_u32 s43, s39, 0x6300
    buffer_load_ushort v24, v7, s[32:35], s41 offen offset:0
    buffer_load_ushort v25, v7, s[32:35], s41 offen offset:1152
    buffer_load_ushort v26, v7, s[32:35], s41 offen offset:2304
    buffer_load_ushort v27, v7, s[32:35], s42 offen offset:0
    buffer_load_ushort v28, v7, s[32:35], s42 offen offset:1152
    buffer_load_ushort v29, v7, s[32:35], s42 offen offset:2304
    buffer_load_ushort v30, v7, s[32:35], s43 offen offset:0
    buffer_load_ushort v31, v7, s[32:35], s43 offen offset:1152
    s_add_u32 s41, s39, 0x9000
    s_add_u32 s42, s39, 0x9d80
    s_add_u32 s43, s39, 0xab00
    buffer_load_ushort v32, v7, s[32:35], s41 offen offset:0
    buffer_load_ushort v33, v7, s[32:35], s41 offen offset:1152
    buffer_load_ushort v34, v7, s[32:35], s41 offen offset:2304
    buffer_load_ushort v35, v7, s[32:35], s42 offen offset:0
    buffer_load_ushort v36, v7, s[32:35], s42 offen offset:1152
    buffer_load_ushort v37, v7, s[32:35], s42 offen offset:2304
    buffer_load_ushort v38, v7, s[32:35], s43 offen offset:0
    buffer_load_ushort v39, v7, s[32:35], s43 offen offset:1152
    s_waitcnt vmcnt(0)
    v_lshl_or_b32 v16, v17, 16, v16
    v_lshl_or_b32 v17, v19, 16, v18
    v_lshl_or_b32 v18, v21, 16, v20
    v_lshl_or_b32 v19, v23, 16, v22
    v_lshl_or_b32 v24, v25, 16, v24
    v_lshl_or_b32 v25, v27, 16, v26
    v_lshl_or_b32 v26, v29, 16, v28
    v_lshl_or_b32 v27, v31, 16, v30
    v_lshl_or_b32 v32, v33, 16, v32
    v_lshl_or_b32 v33, v35, 16, v34
    v_lshl_or_b32 v34, v37, 16, v36
    v_lshl_or_b32 v35, v39, 16, v38
    s_mul_i32 s40, s37, 36
    s_add_u32 s40, s40, s38
    s_mul_i32 s40, s40, 0x240
    s_add_u32 s40, s40, 0x4c0000
    v_mul_u32_u24 v8, 0x120, v6
    v_lshl_add_u32 v8, v2, 4, v8
    v_cmp_gt_u32 vcc, 18, v2
    s_nop 1
    v_cndmask_b32 v8, v9, v8, vcc
    buffer_store_dwordx4 v[16:19], v8, s[20:23], s40 offen offset:0
    buffer_store_dwordx4 v[24:27], v8, s[20:23], s40 offen offset:576
    buffer_store_dwordx4 v[32:35], v8, s[20:23], s40 offen offset:1152
    s_add_u32 s74, s36, 0x400
    s_load_dwordx2 s[68:69], s[0:1], 48
    s_load_dwordx2 s[70:71], s[0:1], 64
    s_load_dwordx2 s[72:73], s[0:1], 32
    v_lshlrev_b32 v250, 7, v1
    s_waitcnt lgkmcnt(0)
    s_add_u32 s75, s74, 0
    s_sub_u32 s96, s75, 0x288
    s_sub_u32 s97, s75, 0x510
    s_cmp_lt_u32 s75, 0x510
    s_cselect_b32 s98, s70, s72
    s_cselect_b32 s99, s71, s73
    s_cselect_b32 s100, s96, s97
    s_cmp_lt_u32 s75, 0x288
    s_cselect_b32 s98, s68, s98
    s_cselect_b32 s99, s69, s99
    s_cselect_b32 s100, s75, s100
    s_mov_b32 s101, 0x510000
    s_cmp_lt_u32 s75, 0x510
    s_cselect_b32 s101, s101, 0xa2000
    s_mov_b32 s76, s98
    s_and_b32 s77, s99, 0xffff
    s_mov_b32 s78, s101
    s_mov_b32 s79, 0x20000
    s_lshl_b32 s100, s100, 13
    buffer_load_dword v251, v250, s[76:79], s100 offen
k1_end_1:
    s_endpgm
.globl k2_kernel
.p2align 8
.type k2_kernel,@function
k2_kernel:
    s_cmp_ge_u32 s2, 0x200
    s_cbranch_scc1 k2_end_6
    s_cmp_ge_u32 s2, 0x100
    s_cbranch_scc1 k2_gemm_5
    s_load_dwordx2 s[12:13], s[0:1], 0x60
    v_lshrrev_b32 v1, 6, v0
    s_nop 0
    v_readfirstlane_b32 s28, v1
    s_and_b32 s29, s2, 7
    s_lshl_b32 s29, s29, 2
    s_bfe_u32 s30, s2, 0x20003
    s_add_u32 s29, s29, s30
    s_lshr_b32 s30, s2, 5
    s_lshl_b32 s30, s30, 2
    s_add_u32 s30, s30, s28
    s_waitcnt lgkmcnt(0)
    s_mov_b32 s16, s12
    s_and_b32 s17, s13, 0xffff
    s_mov_b32 s18, 0x10000000
    s_mov_b32 s19, 0x20000
    s_setprio 3
    v_and_b32 v1, 63, v0
    v_lshlrev_b32 v2, 4, v1
    s_lshl_b32 s33, s28, 12
    s_add_u32 s32, s33, 0x480000
    s_mul_i32 s36, s30, 0x5100
    s_add_u32 s36, s36, 0x4c0000
    v_and_b32 v245, 31, v1
    v_lshrrev_b32 v246, 5, v1
    v_mul_u32_u24 v246, 0x120, v246
    v_lshl_add_u32 v244, v245, 4, v246
    v_mov_b32 v246, 0x7ff00000
    v_cmp_gt_u32 vcc, 18, v245
    s_nop 1
    v_cndmask_b32 v244, v246, v244, vcc
    s_lshr_b32 s50, s28, 1
    s_lshl_b32 s37, s29, 1
    s_add_u32 s37, s37, s50
    s_mul_i32 s37, s37, 0x9000
    s_and_b32 s50, s28, 1
    s_mul_i32 s50, s50, 0x1800
    s_add_u32 s37, s37, s50
    s_add_u32 s37, s37, 0
    s_add_u32 s38, s37, 0x1000
    s_mul_i32 s51, s28, 0x1800
    s_add_u32 s51, s51, 0x8000
    v_add_u32 v3, 0x8000, v2
    s_add_u32 m0, s51, 0
    s_nop 0
    buffer_load_dwordx4 v2, s[16:19], s37 offen offset:0 lds
    buffer_load_dwordx4 v2, s[16:19], s37 offen offset:1024 lds
    buffer_load_dwordx4 v2, s[16:19], s37 offen offset:2048 lds
    buffer_load_dwordx4 v2, s[16:19], s37 offen offset:3072 lds
    s_add_u32 m0, s51, 0x1000
    s_nop 0
    buffer_load_dwordx4 v2, s[16:19], s38 offen offset:0 lds
    buffer_load_dwordx4 v2, s[16:19], s38 offen offset:1024 lds
    s_add_u32 s37, s37, 0x3000
    s_add_u32 s38, s38, 0x3000
    buffer_load_dwordx4 v[100:103], v244, s[16:19], s36 offen offset:0
    buffer_load_dwordx4 v[104:107], v244, s[16:19], s36 offen offset:576
    buffer_load_dwordx4 v[108:111], v244, s[16:19], s36 offen offset:1152
    buffer_load_dwordx4 v[112:115], v244, s[16:19], s36 offen offset:1728
    buffer_load_dwordx4 v[116:119], v244, s[16:19], s36 offen offset:2304
    buffer_load_dwordx4 v[120:123], v244, s[16:19], s36 offen offset:2880
    s_add_u32 s36, s36, 0xd80
    buffer_load_dwordx4 v[124:127], v244, s[16:19], s36 offen offset:0
    buffer_load_dwordx4 v[128:131], v244, s[16:19], s36 offen offset:576
    buffer_load_dwordx4 v[132:135], v244, s[16:19], s36 offen offset:1152
    buffer_load_dwordx4 v[136:139], v244, s[16:19], s36 offen offset:1728
    buffer_load_dwordx4 v[140:143], v244, s[16:19], s36 offen offset:2304
    buffer_load_dwordx4 v[144:147], v244, s[16:19], s36 offen offset:2880
    s_add_u32 m0, s51, 0x6000
    s_nop 0
    buffer_load_dwordx4 v2, s[16:19], s37 offen offset:0 lds
    buffer_load_dwordx4 v2, s[16:19], s37 offen offset:1024 lds
    buffer_load_dwordx4 v2, s[16:19], s37 offen offset:2048 lds
    buffer_load_dwordx4 v2, s[16:19], s37 offen offset:3072 lds
    s_add_u32 m0, s51, 0x7000
    s_nop 0
    buffer_load_dwordx4 v2, s[16:19], s38 offen offset:0 lds
    buffer_load_dwordx4 v2, s[16:19], s38 offen offset:1024 lds
    s_add_u32 s37, s37, 0x3000
    s_add_u32 s38, s38, 0x3000
    s_add_u32 s36, s36, 0xd80
    buffer_load_dwordx4 v[148:151], v244, s[16:19], s36 offen offset:0
    buffer_load_dwordx4 v[152:155], v244, s[16:19], s36 offen offset:576
    buffer_load_dwordx4 v[156:159], v244, s[16:19], s36 offen offset:1152
    buffer_load_dwordx4 v[160:163], v244, s[16:19], s36 offen offset:1728
    buffer_load_dwordx4 v[164:167], v244, s[16:19], s36 offen offset:2304
    buffer_load_dwordx4 v[168:171], v244, s[16:19], s36 offen offset:2880
    s_add_u32 s36, s36, 0xd80
    buffer_load_dwordx4 v[172:175], v244, s[16:19], s36 offen offset:0
    buffer_load_dwordx4 v[176:179], v244, s[16:19], s36 offen offset:576
    buffer_load_dwordx4 v[180:183], v244, s[16:19], s36 offen offset:1152
    buffer_load_dwordx4 v[184:187], v244, s[16:19], s36 offen offset:1728
    buffer_load_dwordx4 v[188:191], v244, s[16:19], s36 offen offset:2304
    buffer_load_dwordx4 v[192:195], v244, s[16:19], s36 offen offset:2880
    s_mov_b32 s35, 0
    s_add_u32 m0, s35, s33
    s_nop 0
    buffer_load_dwordx4 v2, s[16:19], s32 offen offset:0 lds
    s_add_u32 m0, s35, s33
    s_nop 0
    buffer_load_dwordx4 v2, s[16:19], s32 offen offset:1024 lds
    s_add_u32 m0, s35, s33
    s_nop 0
    buffer_load_dwordx4 v2, s[16:19], s32 offen offset:2048 lds
    s_add_u32 m0, s35, s33
    s_nop 0
    buffer_load_dwordx4 v2, s[16:19], s32 offen offset:3072 lds
    s_add_u32 s32, s32, 0x4000
    s_mov_b32 s35, 0x4000
    s_add_u32 m0, s35, s33
    s_nop 0
    buffer_load_dwordx4 v2, s[16:19], s32 offen offset:0 lds
    s_add_u32 m0, s35, s33
    s_nop 0
    buffer_load_dwordx4 v2, s[16:19], s32 offen offset:1024 lds
    s_add_u32 m0, s35, s33
    s_nop 0
    buffer_load_dwordx4 v2, s[16:19], s32 offen offset:2048 lds
    s_add_u32 m0, s35, s33
    s_nop 0
    buffer_load_dwordx4 v2, s[16:19], s32 offen offset:3072 lds
    s_add_u32 s32, s32, 0x4000
    s_add_u32 s36, s36, 0xd80
    buffer_load_dwordx4 v[196:199], v244, s[16:19], s36 offen offset:0
    buffer_load_dwordx4 v[200:203], v244, s[16:19], s36 offen offset:576
    buffer_load_dwordx4 v[204:207], v244, s[16:19], s36 offen offset:1152
    buffer_load_dwordx4 v[208:211], v244, s[16:19], s36 offen offset:1728
    buffer_load_dwordx4 v[212:215], v244, s[16:19], s36 offen offset:2304
    buffer_load_dwordx4 v[216:219], v244, s[16:19], s36 offen offset:2880
    s_add_u32 s36, s36, 0xd80
    buffer_load_dwordx4 v[220:223], v244, s[16:19], s36 offen offset:0
    buffer_load_dwordx4 v[224:227], v244, s[16:19], s36 offen offset:576
    buffer_load_dwordx4 v[228:231], v244, s[16:19], s36 offen offset:1152
    buffer_load_dwordx4 v[232:235], v244, s[16:19], s36 offen offset:1728
    buffer_load_dwordx4 v[236:239], v244, s[16:19], s36 offen offset:2304
    buffer_load_dwordx4 v[240:243], v244, s[16:19], s36 offen offset:2880
    v_mov_b32 v20, 0
    v_mov_b32 v21, 0
    v_mov_b32 v22, 0
    v_mov_b32 v23, 0
    v_mov_b32 v24, 0
    v_mov_b32 v25, 0
    v_mov_b32 v26, 0
    v_mov_b32 v27, 0
    v_mov_b32 v28, 0
    v_mov_b32 v29, 0
    v_mov_b32 v30, 0
    v_mov_b32 v31, 0
    v_mov_b32 v32, 0
    v_mov_b32 v33, 0
    v_mov_b32 v34, 0
    v_mov_b32 v35, 0
    v_mov_b32 v36, 0
    v_mov_b32 v37, 0
    v_mov_b32 v38, 0
    v_mov_b32 v39, 0
    v_mov_b32 v40, 0
    v_mov_b32 v41, 0
    v_mov_b32 v42, 0
    v_mov_b32 v43, 0
    v_mov_b32 v44, 0
    v_mov_b32 v45, 0
    v_mov_b32 v46, 0
    v_mov_b32 v47, 0
    v_mov_b32 v48, 0
    v_mov_b32 v49, 0
    v_mov_b32 v50, 0
    v_mov_b32 v51, 0
    s_waitcnt vmcnt(38)
    s_barrier
    ds_read_b128 v[52:55], v3 offset:0
    ds_read_b128 v[56:59], v3 offset:12288
    ds_read_b128 v[60:63], v3 offset:1024
    ds_read_b128 v[64:67], v3 offset:13312
    ds_read_b128 v[68:71], v3 offset:2048
    ds_read_b128 v[72:75], v3 offset:14336
    ds_read_b128 v[76:79], v3 offset:3072
    ds_read_b128 v[80:83], v3 offset:15360
    ds_read_b128 v[84:87], v3 offset:4096
    ds_read_b128 v[88:91], v3 offset:16384
    ds_read_b128 v[92:95], v3 offset:5120
    ds_read_b128 v[96:99], v3 offset:17408
    s_waitcnt lgkmcnt(10)
    v_mfma_f32_32x32x16_bf16 v[20:35], v[100:103], v[52:55], v[20:35]
    v_mfma_f32_32x32x16_bf16 v[36:51], v[100:103], v[56:59], v[36:51]
    s_waitcnt lgkmcnt(8)
    v_mfma_f32_32x32x16_bf16 v[20:35], v[104:107], v[60:63], v[20:35]
    v_mfma_f32_32x32x16_bf16 v[36:51], v[104:107], v[64:67], v[36:51]
    s_waitcnt lgkmcnt(6)
    v_mfma_f32_32x32x16_bf16 v[20:35], v[108:111], v[68:71], v[20:35]
    v_mfma_f32_32x32x16_bf16 v[36:51], v[108:111], v[72:75], v[36:51]
    s_waitcnt lgkmcnt(4)
    v_mfma_f32_32x32x16_bf16 v[20:35], v[112:115], v[76:79], v[20:35]
    v_mfma_f32_32x32x16_bf16 v[36:51], v[112:115], v[80:83], v[36:51]
    s_waitcnt lgkmcnt(2)
    v_mfma_f32_32x32x16_bf16 v[20:35], v[116:119], v[84:87], v[20:35]
    v_mfma_f32_32x32x16_bf16 v[36:51], v[116:119], v[88:91], v[36:51]
    s_waitcnt lgkmcnt(0)
    v_mfma_f32_32x32x16_bf16 v[20:35], v[120:123], v[92:95], v[20:35]
    v_mfma_f32_32x32x16_bf16 v[36:51], v[120:123], v[96:99], v[36:51]
    ds_read_b128 v[52:55], v3 offset:6144
    ds_read_b128 v[56:59], v3 offset:18432
    ds_read_b128 v[60:63], v3 offset:7168
    ds_read_b128 v[64:67], v3 offset:19456
    ds_read_b128 v[68:71], v3 offset:8192
    ds_read_b128 v[72:75], v3 offset:20480
    ds_read_b128 v[76:79], v3 offset:9216
    ds_read_b128 v[80:83], v3 offset:21504
    ds_read_b128 v[84:87], v3 offset:10240
    ds_read_b128 v[88:91], v3 offset:22528
    ds_read_b128 v[92:95], v3 offset:11264
    ds_read_b128 v[96:99], v3 offset:23552
    s_waitcnt lgkmcnt(10)
    v_mfma_f32_32x32x16_bf16 v[20:35], v[124:127], v[52:55], v[20:35]
    v_mfma_f32_32x32x16_bf16 v[36:51], v[124:127], v[56:59], v[36:51]
    s_waitcnt lgkmcnt(8)
    v_mfma_f32_32x32x16_bf16 v[20:35], v[128:131], v[60:63], v[20:35]
    v_mfma_f32_32x32x16_bf16 v[36:51], v[128:131], v[64:67], v[36:51]
    s_waitcnt lgkmcnt(6)
    v_mfma_f32_32x32x16_bf16 v[20:35], v[132:135], v[68:71], v[20:35]
    v_mfma_f32_32x32x16_bf16 v[36:51], v[132:135], v[72:75], v[36:51]
    s_waitcnt lgkmcnt(4)
    v_mfma_f32_32x32x16_bf16 v[20:35], v[136:139], v[76:79], v[20:35]
    v_mfma_f32_32x32x16_bf16 v[36:51], v[136:139], v[80:83], v[36:51]
    s_waitcnt lgkmcnt(2)
    v_mfma_f32_32x32x16_bf16 v[20:35], v[140:143], v[84:87], v[20:35]
    v_mfma_f32_32x32x16_bf16 v[36:51], v[140:143], v[88:91], v[36:51]
    s_waitcnt lgkmcnt(0)
    v_mfma_f32_32x32x16_bf16 v[20:35], v[144:147], v[92:95], v[20:35]
    v_mfma_f32_32x32x16_bf16 v[36:51], v[144:147], v[96:99], v[36:51]
    s_barrier
    s_add_u32 m0, s51, 0
    s_nop 0
    buffer_load_dwordx4 v2, s[16:19], s37 offen offset:0 lds
    buffer_load_dwordx4 v2, s[16:19], s37 offen offset:1024 lds
    buffer_load_dwordx4 v2, s[16:19], s37 offen offset:2048 lds
    buffer_load_dwordx4 v2, s[16:19], s37 offen offset:3072 lds
    s_add_u32 m0, s51, 0x1000
    s_nop 0
    buffer_load_dwordx4 v2, s[16:19], s38 offen offset:0 lds
    buffer_load_dwordx4 v2, s[16:19], s38 offen offset:1024 lds
    s_add_u32 s37, s37, 0x3000
    s_add_u32 s38, s38, 0x3000
    s_waitcnt vmcnt(26)
    s_barrier
    ds_read_b128 v[52:55], v3 offset:24576
    ds_read_b128 v[56:59], v3 offset:36864
    ds_read_b128 v[60:63], v3 offset:25600
    ds_read_b128 v[64:67], v3 offset:37888
    ds_read_b128 v[68:71], v3 offset:26624
    ds_read_b128 v[72:75], v3 offset:38912
    ds_read_b128 v[76:79], v3 offset:27648
    ds_read_b128 v[80:83], v3 offset:39936
    ds_read_b128 v[84:87], v3 offset:28672
    ds_read_b128 v[88:91], v3 offset:40960
    ds_read_b128 v[92:95], v3 offset:29696
    ds_read_b128 v[96:99], v3 offset:41984
    s_waitcnt lgkmcnt(10)
    v_mfma_f32_32x32x16_bf16 v[20:35], v[148:151], v[52:55], v[20:35]
    v_mfma_f32_32x32x16_bf16 v[36:51], v[148:151], v[56:59], v[36:51]
    s_waitcnt lgkmcnt(8)
    v_mfma_f32_32x32x16_bf16 v[20:35], v[152:155], v[60:63], v[20:35]
    v_mfma_f32_32x32x16_bf16 v[36:51], v[152:155], v[64:67], v[36:51]
    s_waitcnt lgkmcnt(6)
    v_mfma_f32_32x32x16_bf16 v[20:35], v[156:159], v[68:71], v[20:35]
    v_mfma_f32_32x32x16_bf16 v[36:51], v[156:159], v[72:75], v[36:51]
    s_waitcnt lgkmcnt(4)
    v_mfma_f32_32x32x16_bf16 v[20:35], v[160:163], v[76:79], v[20:35]
    v_mfma_f32_32x32x16_bf16 v[36:51], v[160:163], v[80:83], v[36:51]
    s_waitcnt lgkmcnt(2)
    v_mfma_f32_32x32x16_bf16 v[20:35], v[164:167], v[84:87], v[20:35]
    v_mfma_f32_32x32x16_bf16 v[36:51], v[164:167], v[88:91], v[36:51]
    s_waitcnt lgkmcnt(0)
    v_mfma_f32_32x32x16_bf16 v[20:35], v[168:171], v[92:95], v[20:35]
    v_mfma_f32_32x32x16_bf16 v[36:51], v[168:171], v[96:99], v[36:51]
    ds_read_b128 v[52:55], v3 offset:30720
    ds_read_b128 v[56:59], v3 offset:43008
    ds_read_b128 v[60:63], v3 offset:31744
    ds_read_b128 v[64:67], v3 offset:44032
    ds_read_b128 v[68:71], v3 offset:32768
    ds_read_b128 v[72:75], v3 offset:45056
    ds_read_b128 v[76:79], v3 offset:33792
    ds_read_b128 v[80:83], v3 offset:46080
    ds_read_b128 v[84:87], v3 offset:34816
    ds_read_b128 v[88:91], v3 offset:47104
    ds_read_b128 v[92:95], v3 offset:35840
    ds_read_b128 v[96:99], v3 offset:48128
    s_waitcnt lgkmcnt(10)
    v_mfma_f32_32x32x16_bf16 v[20:35], v[172:175], v[52:55], v[20:35]
    v_mfma_f32_32x32x16_bf16 v[36:51], v[172:175], v[56:59], v[36:51]
    s_waitcnt lgkmcnt(8)
    v_mfma_f32_32x32x16_bf16 v[20:35], v[176:179], v[60:63], v[20:35]
    v_mfma_f32_32x32x16_bf16 v[36:51], v[176:179], v[64:67], v[36:51]
    s_waitcnt lgkmcnt(6)
    v_mfma_f32_32x32x16_bf16 v[20:35], v[180:183], v[68:71], v[20:35]
    v_mfma_f32_32x32x16_bf16 v[36:51], v[180:183], v[72:75], v[36:51]
    s_waitcnt lgkmcnt(4)
    v_mfma_f32_32x32x16_bf16 v[20:35], v[184:187], v[76:79], v[20:35]
    v_mfma_f32_32x32x16_bf16 v[36:51], v[184:187], v[80:83], v[36:51]
    s_waitcnt lgkmcnt(2)
    v_mfma_f32_32x32x16_bf16 v[20:35], v[188:191], v[84:87], v[20:35]
    v_mfma_f32_32x32x16_bf16 v[36:51], v[188:191], v[88:91], v[36:51]
    s_waitcnt lgkmcnt(0)
    v_mfma_f32_32x32x16_bf16 v[20:35], v[192:195], v[92:95], v[20:35]
    v_mfma_f32_32x32x16_bf16 v[36:51], v[192:195], v[96:99], v[36:51]
    s_waitcnt vmcnt(0)
    s_barrier
    ds_read_b128 v[52:55], v3 offset:0
    ds_read_b128 v[56:59], v3 offset:12288
    ds_read_b128 v[60:63], v3 offset:1024
    ds_read_b128 v[64:67], v3 offset:13312
    ds_read_b128 v[68:71], v3 offset:2048
    ds_read_b128 v[72:75], v3 offset:14336
    ds_read_b128 v[76:79], v3 offset:3072
    ds_read_b128 v[80:83], v3 offset:15360
    ds_read_b128 v[84:87], v3 offset:4096
    ds_read_b128 v[88:91], v3 offset:16384
    ds_read_b128 v[92:95], v3 offset:5120
    ds_read_b128 v[96:99], v3 offset:17408
    s_waitcnt lgkmcnt(10)
    v_mfma_f32_32x32x16_bf16 v[20:35], v[196:199], v[52:55], v[20:35]
    v_mfma_f32_32x32x16_bf16 v[36:51], v[196:199], v[56:59], v[36:51]
    s_waitcnt lgkmcnt(8)
    v_mfma_f32_32x32x16_bf16 v[20:35], v[200:203], v[60:63], v[20:35]
    v_mfma_f32_32x32x16_bf16 v[36:51], v[200:203], v[64:67], v[36:51]
    s_waitcnt lgkmcnt(6)
    v_mfma_f32_32x32x16_bf16 v[20:35], v[204:207], v[68:71], v[20:35]
    v_mfma_f32_32x32x16_bf16 v[36:51], v[204:207], v[72:75], v[36:51]
    s_waitcnt lgkmcnt(4)
    v_mfma_f32_32x32x16_bf16 v[20:35], v[208:211], v[76:79], v[20:35]
    v_mfma_f32_32x32x16_bf16 v[36:51], v[208:211], v[80:83], v[36:51]
    s_waitcnt lgkmcnt(2)
    v_mfma_f32_32x32x16_bf16 v[20:35], v[212:215], v[84:87], v[20:35]
    v_mfma_f32_32x32x16_bf16 v[36:51], v[212:215], v[88:91], v[36:51]
    s_waitcnt lgkmcnt(0)
    v_mfma_f32_32x32x16_bf16 v[20:35], v[216:219], v[92:95], v[20:35]
    v_mfma_f32_32x32x16_bf16 v[36:51], v[216:219], v[96:99], v[36:51]
    ds_read_b128 v[52:55], v3 offset:6144
    ds_read_b128 v[56:59], v3 offset:18432
    ds_read_b128 v[60:63], v3 offset:7168
    ds_read_b128 v[64:67], v3 offset:19456
    ds_read_b128 v[68:71], v3 offset:8192
    ds_read_b128 v[72:75], v3 offset:20480
    ds_read_b128 v[76:79], v3 offset:9216
    ds_read_b128 v[80:83], v3 offset:21504
    ds_read_b128 v[84:87], v3 offset:10240
    ds_read_b128 v[88:91], v3 offset:22528
    ds_read_b128 v[92:95], v3 offset:11264
    ds_read_b128 v[96:99], v3 offset:23552
    s_waitcnt lgkmcnt(10)
    v_mfma_f32_32x32x16_bf16 v[20:35], v[220:223], v[52:55], v[20:35]
    v_mfma_f32_32x32x16_bf16 v[36:51], v[220:223], v[56:59], v[36:51]
    s_waitcnt lgkmcnt(8)
    v_mfma_f32_32x32x16_bf16 v[20:35], v[224:227], v[60:63], v[20:35]
    v_mfma_f32_32x32x16_bf16 v[36:51], v[224:227], v[64:67], v[36:51]
    s_waitcnt lgkmcnt(6)
    v_mfma_f32_32x32x16_bf16 v[20:35], v[228:231], v[68:71], v[20:35]
    v_mfma_f32_32x32x16_bf16 v[36:51], v[228:231], v[72:75], v[36:51]
    s_waitcnt lgkmcnt(4)
    v_mfma_f32_32x32x16_bf16 v[20:35], v[232:235], v[76:79], v[20:35]
    v_mfma_f32_32x32x16_bf16 v[36:51], v[232:235], v[80:83], v[36:51]
    s_waitcnt lgkmcnt(2)
    v_mfma_f32_32x32x16_bf16 v[20:35], v[236:239], v[84:87], v[20:35]
    v_mfma_f32_32x32x16_bf16 v[36:51], v[236:239], v[88:91], v[36:51]
    s_waitcnt lgkmcnt(0)
    v_mfma_f32_32x32x16_bf16 v[20:35], v[240:243], v[92:95], v[20:35]
    v_mfma_f32_32x32x16_bf16 v[36:51], v[240:243], v[96:99], v[36:51]
    s_mov_b32 s39, 0x3eae1a93
    s_nop 9
    v_mul_f32 v20, s39, v20
    s_nop 8
    v_mul_f32 v21, s39, v21
    s_nop 7
    v_mul_f32 v22, s39, v22
    s_nop 6
    v_mul_f32 v23, s39, v23
    s_nop 5
    v_mul_f32 v24, s39, v24
    s_nop 4
    v_mul_f32 v25, s39, v25
    s_nop 3
    v_mul_f32 v26, s39, v26
    s_nop 2
    v_mul_f32 v27, s39, v27
    s_nop 1
    v_mul_f32 v28, s39, v28
    s_nop 0
    v_mul_f32 v29, s39, v29
    v_mul_f32 v30, s39, v30
    v_mul_f32 v31, s39, v31
    v_mul_f32 v32, s39, v32
    v_mul_f32 v33, s39, v33
    v_mul_f32 v34, s39, v34
    v_mul_f32 v35, s39, v35
    v_cvt_pk_bf16_f32 v4, v20, v21
    v_cvt_pk_bf16_f32 v5, v22, v23
    v_cvt_pk_bf16_f32 v6, v24, v25
    v_cvt_pk_bf16_f32 v7, v26, v27
    v_cvt_pk_bf16_f32 v8, v28, v29
    v_cvt_pk_bf16_f32 v9, v30, v31
    v_cvt_pk_bf16_f32 v10, v32, v33
    v_cvt_pk_bf16_f32 v11, v34, v35
    v_mul_f32 v36, s39, v36
    v_mul_f32 v37, s39, v37
    v_mul_f32 v38, s39, v38
    v_mul_f32 v39, s39, v39
    v_mul_f32 v40, s39, v40
    v_mul_f32 v41, s39, v41
    v_mul_f32 v42, s39, v42
    v_mul_f32 v43, s39, v43
    v_mul_f32 v44, s39, v44
    v_mul_f32 v45, s39, v45
    v_mul_f32 v46, s39, v46
    v_mul_f32 v47, s39, v47
    v_mul_f32 v48, s39, v48
    v_mul_f32 v49, s39, v49
    v_mul_f32 v50, s39, v50
    v_mul_f32 v51, s39, v51
    v_cvt_pk_bf16_f32 v12, v36, v37
    v_cvt_pk_bf16_f32 v13, v38, v39
    v_cvt_pk_bf16_f32 v14, v40, v41
    v_cvt_pk_bf16_f32 v15, v42, v43
    v_cvt_pk_bf16_f32 v16, v44, v45
    v_cvt_pk_bf16_f32 v17, v46, v47
    v_cvt_pk_bf16_f32 v18, v48, v49
    v_cvt_pk_bf16_f32 v19, v50, v51
    v_mov_b32 v68, 0
    v_mov_b32 v69, 0
    v_mov_b32 v70, 0
    v_mov_b32 v71, 0
    v_mov_b32 v72, 0
    v_mov_b32 v73, 0
    v_mov_b32 v74, 0
    v_mov_b32 v75, 0
    v_mov_b32 v76, 0
    v_mov_b32 v77, 0
    v_mov_b32 v78, 0
    v_mov_b32 v79, 0
    v_mov_b32 v80, 0
    v_mov_b32 v81, 0
    v_mov_b32 v82, 0
    v_mov_b32 v83, 0
    v_mov_b32 v164, 0
    v_mov_b32 v9, 0
    v_mov_b32 v84, 0
    v_mov_b32 v85, 0
    v_mov_b32 v86, 0
    v_mov_b32 v87, 0
    v_mov_b32 v88, 0
    v_mov_b32 v89, 0
    v_mov_b32 v90, 0
    v_mov_b32 v91, 0
    v_mov_b32 v92, 0
    v_mov_b32 v93, 0
    v_mov_b32 v94, 0
    v_mov_b32 v95, 0
    v_mov_b32 v96, 0
    v_mov_b32 v97, 0
    v_mov_b32 v98, 0
    v_mov_b32 v99, 0
    v_mov_b32 v165, 0
    v_mov_b32 v17, 0
    s_mov_b32 s40, 0xff800000
    s_mov_b32 s41, 0xff800000
    s_mov_b32 s53, 0x4b800000
    s_waitcnt vmcnt(0)
    s_barrier
    v_mov_b32 v172, v2
    v_add_u32 v173, 0x4000, v2
    s_mov_b32 s43, 0
    s_mov_b32 s44, 0x4000
    s_mov_b32 s45, 0x8000
    ds_read_b128 v[20:23], v172 offset:0
    ds_read_b128 v[24:27], v172 offset:1024
    ds_read_b128 v[28:31], v172 offset:4096
    ds_read_b128 v[32:35], v172 offset:5120
    ds_read_b128 v[36:39], v172 offset:2048
    ds_read_b128 v[40:43], v172 offset:3072
    s_waitcnt lgkmcnt(0)
    v_mfma_f32_32x32x16_bf16 v[100:115], v[20:23], v[4:7], 0
    v_mfma_f32_32x32x16_bf16 v[100:115], v[24:27], v[8:11], v[100:115]
    v_mfma_f32_32x32x16_bf16 v[116:131], v[20:23], v[12:15], 0
    v_mfma_f32_32x32x16_bf16 v[116:131], v[24:27], v[16:19], v[116:131]
    s_nop 9
    v_max3_f32 v166, v100, v101, v102
    s_nop 8
    v_max3_f32 v166, v166, v103, v104
    s_nop 7
    v_max3_f32 v166, v166, v105, v106
    s_nop 6
    v_max3_f32 v166, v166, v107, v108
    s_nop 5
    v_max3_f32 v166, v166, v109, v110
    s_nop 4
    v_max3_f32 v166, v166, v111, v112
    s_nop 3
    v_max3_f32 v166, v166, v113, v114
    s_nop 2
    v_max_f32 v166, v166, v115
    s_nop 3
    v_max3_f32 v167, v116, v117, v118
    s_nop 2
    v_max3_f32 v167, v167, v119, v120
    s_nop 1
    v_max3_f32 v167, v167, v121, v122
    s_nop 0
    v_max3_f32 v167, v167, v123, v124
    v_max3_f32 v167, v167, v125, v126
    v_max3_f32 v167, v167, v127, v128
    v_max3_f32 v167, v167, v129, v130
    v_max_f32 v167, v167, v131
    v_mov_b32 v168, v166
    v_mov_b32 v169, v166
    s_nop 1
    v_permlane32_swap_b32 v168, v169
    v_max_f32 v168, v168, v169
    v_max_f32 v168, s41, v168
    v_add_f32 v168, v164, v168
    v_and_b32 v168, 0xffff0000, v168
    v_sub_f32 v169, v168, v164
    v_mov_b32 v164, v168
    v_xor_b32 v170, 0x80000000, v168
    v_lshrrev_b32 v9, 16, v170
    v_sub_f32 v100, v100, v169
    v_sub_f32 v101, v101, v169
    v_sub_f32 v102, v102, v169
    v_sub_f32 v103, v103, v169
    v_sub_f32 v104, v104, v169
    v_sub_f32 v105, v105, v169
    v_sub_f32 v106, v106, v169
    v_sub_f32 v107, v107, v169
    v_sub_f32 v108, v108, v169
    v_sub_f32 v109, v109, v169
    v_sub_f32 v110, v110, v169
    v_sub_f32 v111, v111, v169
    v_sub_f32 v112, v112, v169
    v_sub_f32 v113, v113, v169
    v_sub_f32 v114, v114, v169
    v_sub_f32 v115, v115, v169
    v_sub_f32 v170, 0, v169
    v_min_f32 v170, 0, v170
    v_exp_f32 v170, v170
    s_nop 0
    v_mul_f32 v68, v68, v170
    v_mul_f32 v69, v69, v170
    v_mul_f32 v70, v70, v170
    v_mul_f32 v71, v71, v170
    v_mul_f32 v72, v72, v170
    v_mul_f32 v73, v73, v170
    v_mul_f32 v74, v74, v170
    v_mul_f32 v75, v75, v170
    v_mul_f32 v76, v76, v170
    v_mul_f32 v77, v77, v170
    v_mul_f32 v78, v78, v170
    v_mul_f32 v79, v79, v170
    v_mul_f32 v80, v80, v170
    v_mul_f32 v81, v81, v170
    v_mul_f32 v82, v82, v170
    v_mul_f32 v83, v83, v170
    v_mov_b32 v168, v167
    v_mov_b32 v169, v167
    s_nop 1
    v_permlane32_swap_b32 v168, v169
    v_max_f32 v168, v168, v169
    v_max_f32 v168, s41, v168
    v_add_f32 v168, v165, v168
    v_and_b32 v168, 0xffff0000, v168
    v_sub_f32 v169, v168, v165
    v_mov_b32 v165, v168
    v_xor_b32 v170, 0x80000000, v168
    v_lshrrev_b32 v17, 16, v170
    v_sub_f32 v116, v116, v169
    v_sub_f32 v117, v117, v169
    v_sub_f32 v118, v118, v169
    v_sub_f32 v119, v119, v169
    v_sub_f32 v120, v120, v169
    v_sub_f32 v121, v121, v169
    v_sub_f32 v122, v122, v169
    v_sub_f32 v123, v123, v169
    v_sub_f32 v124, v124, v169
    v_sub_f32 v125, v125, v169
    v_sub_f32 v126, v126, v169
    v_sub_f32 v127, v127, v169
    v_sub_f32 v128, v128, v169
    v_sub_f32 v129, v129, v169
    v_sub_f32 v130, v130, v169
    v_sub_f32 v131, v131, v169
    v_sub_f32 v170, 0, v169
    v_min_f32 v170, 0, v170
    v_exp_f32 v170, v170
    s_nop 0
    v_mul_f32 v84, v84, v170
    v_mul_f32 v85, v85, v170
    v_mul_f32 v86, v86, v170
    v_mul_f32 v87, v87, v170
    v_mul_f32 v88, v88, v170
    v_mul_f32 v89, v89, v170
    v_mul_f32 v90, v90, v170
    v_mul_f32 v91, v91, v170
    v_mul_f32 v92, v92, v170
    v_mul_f32 v93, v93, v170
    v_mul_f32 v94, v94, v170
    v_mul_f32 v95, v95, v170
    v_mul_f32 v96, v96, v170
    v_mul_f32 v97, v97, v170
    v_mul_f32 v98, v98, v170
    v_mul_f32 v99, v99, v170
    s_mov_b32 s42, 0
att_loop_9:
    s_waitcnt vmcnt(0) lgkmcnt(0)
    s_barrier
    s_cmp_lt_u32 s42, 14
    s_cbranch_scc0 att_nd_10
    s_add_u32 m0, s45, s33
    s_nop 0
    buffer_load_dwordx4 v2, s[16:19], s32 offen offset:0 lds
    s_add_u32 m0, s45, s33
    s_nop 0
    buffer_load_dwordx4 v2, s[16:19], s32 offen offset:1024 lds
    s_add_u32 m0, s45, s33
    s_nop 0
    buffer_load_dwordx4 v2, s[16:19], s32 offen offset:2048 lds
    s_add_u32 m0, s45, s33
    s_nop 0
    buffer_load_dwordx4 v2, s[16:19], s32 offen offset:3072 lds
    s_add_u32 s32, s32, 0x4000
att_nd_10:
    v_max_f32 v168, v78, v94
    v_cmp_lt_f32 vcc, s53, v168
    s_cbranch_vccnz att_resc_11
att_back_12:
    v_exp_f32 v100, v100
    v_exp_f32 v101, v101
    v_exp_f32 v102, v102
    v_exp_f32 v103, v103
    v_mfma_f32_32x32x16_bf16 v[132:147], v[28:31], v[4:7], 0
    v_exp_f32 v104, v104
    v_exp_f32 v105, v105
    v_exp_f32 v106, v106
    v_exp_f32 v107, v107
    v_mfma_f32_32x32x16_bf16 v[132:147], v[32:35], v[8:11], v[132:147]
    v_exp_f32 v108, v108
    v_exp_f32 v109, v109
    v_exp_f32 v110, v110
    v_exp_f32 v111, v111
    v_mfma_f32_32x32x16_bf16 v[148:163], v[28:31], v[12:15], 0
    v_exp_f32 v112, v112
    v_exp_f32 v113, v113
    v_exp_f32 v114, v114
    v_exp_f32 v115, v115
    v_mfma_f32_32x32x16_bf16 v[148:163], v[32:35], v[16:19], v[148:163]
    ds_read_b128 v[20:23], v172 offset:8192
    ds_read_b128 v[24:27], v172 offset:9216
    v_cvt_pk_bf16_f32 v52, v100, v101
    v_cvt_pk_bf16_f32 v53, v102, v103
    v_cvt_pk_bf16_f32 v54, v104, v105
    v_cvt_pk_bf16_f32 v55, v106, v107
    v_cvt_pk_bf16_f32 v56, v108, v109
    v_cvt_pk_bf16_f32 v57, v110, v111
    v_cvt_pk_bf16_f32 v58, v112, v113
    v_cvt_pk_bf16_f32 v59, v114, v115
    s_waitcnt lgkmcnt(2)
    v_mfma_f32_32x32x16_bf16 v[68:83], v[36:39], v[52:55], v[68:83]
    v_exp_f32 v116, v116
    v_exp_f32 v117, v117
    v_exp_f32 v118, v118
    v_exp_f32 v119, v119
    v_mfma_f32_32x32x16_bf16 v[68:83], v[40:43], v[56:59], v[68:83]
    v_exp_f32 v120, v120
    v_exp_f32 v121, v121
    v_exp_f32 v122, v122
    v_exp_f32 v123, v123
    v_exp_f32 v124, v124
    v_exp_f32 v125, v125
    v_exp_f32 v126, v126
    v_exp_f32 v127, v127
    v_cvt_pk_bf16_f32 v60, v116, v117
    v_cvt_pk_bf16_f32 v61, v118, v119
    v_cvt_pk_bf16_f32 v62, v120, v121
    v_cvt_pk_bf16_f32 v63, v122, v123
    s_nop 1
    v_mfma_f32_32x32x16_bf16 v[84:99], v[36:39], v[60:63], v[84:99]
    v_exp_f32 v128, v128
    v_exp_f32 v129, v129
    v_exp_f32 v130, v130
    v_exp_f32 v131, v131
    v_cvt_pk_bf16_f32 v64, v124, v125
    v_cvt_pk_bf16_f32 v65, v126, v127
    v_cvt_pk_bf16_f32 v66, v128, v129
    v_cvt_pk_bf16_f32 v67, v130, v131
    ds_read_b128 v[44:47], v172 offset:6144
    ds_read_b128 v[48:51], v172 offset:7168
    v_mfma_f32_32x32x16_bf16 v[84:99], v[40:43], v[64:67], v[84:99]
    s_waitcnt lgkmcnt(2)
    v_exp_f32 v132, v132
    v_exp_f32 v133, v133
    v_exp_f32 v134, v134
    v_exp_f32 v135, v135
    v_mfma_f32_32x32x16_bf16 v[100:115], v[20:23], v[4:7], 0
    v_exp_f32 v136, v136
    v_exp_f32 v137, v137
    v_exp_f32 v138, v138
    v_exp_f32 v139, v139
    v_mfma_f32_32x32x16_bf16 v[100:115], v[24:27], v[8:11], v[100:115]
    v_exp_f32 v140, v140
    v_exp_f32 v141, v141
    v_exp_f32 v142, v142
    v_exp_f32 v143, v143
    v_mfma_f32_32x32x16_bf16 v[116:131], v[20:23], v[12:15], 0
    v_exp_f32 v144, v144
    v_exp_f32 v145, v145
    v_exp_f32 v146, v146
    v_exp_f32 v147, v147
    v_mfma_f32_32x32x16_bf16 v[116:131], v[24:27], v[16:19], v[116:131]
    ds_read_b128 v[28:31], v172 offset:12288
    ds_read_b128 v[32:35], v172 offset:13312
    v_cvt_pk_bf16_f32 v52, v132, v133
    v_cvt_pk_bf16_f32 v53, v134, v135
    v_cvt_pk_bf16_f32 v54, v136, v137
    v_cvt_pk_bf16_f32 v55, v138, v139
    v_cvt_pk_bf16_f32 v56, v140, v141
    v_cvt_pk_bf16_f32 v57, v142, v143
    v_cvt_pk_bf16_f32 v58, v144, v145
    v_cvt_pk_bf16_f32 v59, v146, v147
    s_waitcnt lgkmcnt(2)
    v_mfma_f32_32x32x16_bf16 v[68:83], v[44:47], v[52:55], v[68:83]
    v_exp_f32 v148, v148
    v_exp_f32 v149, v149
    v_exp_f32 v150, v150
    v_exp_f32 v151, v151
    v_mfma_f32_32x32x16_bf16 v[68:83], v[48:51], v[56:59], v[68:83]
    v_exp_f32 v152, v152
    v_exp_f32 v153, v153
    v_exp_f32 v154, v154
    v_exp_f32 v155, v155
    v_exp_f32 v156, v156
    v_exp_f32 v157, v157
    v_exp_f32 v158, v158
    v_exp_f32 v159, v159
    v_cvt_pk_bf16_f32 v60, v148, v149
    v_cvt_pk_bf16_f32 v61, v150, v151
    v_cvt_pk_bf16_f32 v62, v152, v153
    v_cvt_pk_bf16_f32 v63, v154, v155
    s_nop 1
    v_mfma_f32_32x32x16_bf16 v[84:99], v[44:47], v[60:63], v[84:99]
    v_exp_f32 v160, v160
    v_exp_f32 v161, v161
    v_exp_f32 v162, v162
    v_exp_f32 v163, v163
    v_cvt_pk_bf16_f32 v64, v156, v157
    v_cvt_pk_bf16_f32 v65, v158, v159
    v_cvt_pk_bf16_f32 v66, v160, v161
    v_cvt_pk_bf16_f32 v67, v162, v163
    ds_read_b128 v[36:39], v172 offset:10240
    ds_read_b128 v[40:43], v172 offset:11264
    v_mfma_f32_32x32x16_bf16 v[84:99], v[48:51], v[64:67], v[84:99]
    s_waitcnt lgkmcnt(2)
    v_exp_f32 v100, v100
    v_exp_f32 v101, v101
    v_exp_f32 v102, v102
    v_exp_f32 v103, v103
    v_mfma_f32_32x32x16_bf16 v[132:147], v[28:31], v[4:7], 0
    v_exp_f32 v104, v104
    v_exp_f32 v105, v105
    v_exp_f32 v106, v106
    v_exp_f32 v107, v107
    v_mfma_f32_32x32x16_bf16 v[132:147], v[32:35], v[8:11], v[132:147]
    v_exp_f32 v108, v108
    v_exp_f32 v109, v109
    v_exp_f32 v110, v110
    v_exp_f32 v111, v111
    v_mfma_f32_32x32x16_bf16 v[148:163], v[28:31], v[12:15], 0
    v_exp_f32 v112, v112
    v_exp_f32 v113, v113
    v_exp_f32 v114, v114
    v_exp_f32 v115, v115
    v_mfma_f32_32x32x16_bf16 v[148:163], v[32:35], v[16:19], v[148:163]
    ds_read_b128 v[20:23], v173 offset:0
    ds_read_b128 v[24:27], v173 offset:1024
    v_cvt_pk_bf16_f32 v52, v100, v101
    v_cvt_pk_bf16_f32 v53, v102, v103
    v_cvt_pk_bf16_f32 v54, v104, v105
    v_cvt_pk_bf16_f32 v55, v106, v107
    v_cvt_pk_bf16_f32 v56, v108, v109
    v_cvt_pk_bf16_f32 v57, v110, v111
    v_cvt_pk_bf16_f32 v58, v112, v113
    v_cvt_pk_bf16_f32 v59, v114, v115
    s_waitcnt lgkmcnt(2)
    v_mfma_f32_32x32x16_bf16 v[68:83], v[36:39], v[52:55], v[68:83]
    v_exp_f32 v116, v116
    v_exp_f32 v117, v117
    v_exp_f32 v118, v118
    v_exp_f32 v119, v119
    v_mfma_f32_32x32x16_bf16 v[68:83], v[40:43], v[56:59], v[68:83]
    v_exp_f32 v120, v120
    v_exp_f32 v121, v121
    v_exp_f32 v122, v122
    v_exp_f32 v123, v123
    v_exp_f32 v124, v124
    v_exp_f32 v125, v125
    v_exp_f32 v126, v126
    v_exp_f32 v127, v127
    v_cvt_pk_bf16_f32 v60, v116, v117
    v_cvt_pk_bf16_f32 v61, v118, v119
    v_cvt_pk_bf16_f32 v62, v120, v121
    v_cvt_pk_bf16_f32 v63, v122, v123
    s_nop 1
    v_mfma_f32_32x32x16_bf16 v[84:99], v[36:39], v[60:63], v[84:99]
    v_exp_f32 v128, v128
    v_exp_f32 v129, v129
    v_exp_f32 v130, v130
    v_exp_f32 v131, v131
    v_cvt_pk_bf16_f32 v64, v124, v125
    v_cvt_pk_bf16_f32 v65, v126, v127
    v_cvt_pk_bf16_f32 v66, v128, v129
    v_cvt_pk_bf16_f32 v67, v130, v131
    ds_read_b128 v[44:47], v172 offset:14336
    ds_read_b128 v[48:51], v172 offset:15360
    v_mfma_f32_32x32x16_bf16 v[84:99], v[40:43], v[64:67], v[84:99]
    s_waitcnt lgkmcnt(2)
    v_exp_f32 v132, v132
    v_exp_f32 v133, v133
    v_exp_f32 v134, v134
    v_exp_f32 v135, v135
    v_mfma_f32_32x32x16_bf16 v[100:115], v[20:23], v[4:7], 0
    v_exp_f32 v136, v136
    v_exp_f32 v137, v137
    v_exp_f32 v138, v138
    v_exp_f32 v139, v139
    v_mfma_f32_32x32x16_bf16 v[100:115], v[24:27], v[8:11], v[100:115]
    v_exp_f32 v140, v140
    v_exp_f32 v141, v141
    v_exp_f32 v142, v142
    v_exp_f32 v143, v143
    v_mfma_f32_32x32x16_bf16 v[116:131], v[20:23], v[12:15], 0
    v_exp_f32 v144, v144
    v_exp_f32 v145, v145
    v_exp_f32 v146, v146
    v_exp_f32 v147, v147
    v_mfma_f32_32x32x16_bf16 v[116:131], v[24:27], v[16:19], v[116:131]
    ds_read_b128 v[28:31], v173 offset:4096
    ds_read_b128 v[32:35], v173 offset:5120
    v_cvt_pk_bf16_f32 v52, v132, v133
    v_cvt_pk_bf16_f32 v53, v134, v135
    v_cvt_pk_bf16_f32 v54, v136, v137
    v_cvt_pk_bf16_f32 v55, v138, v139
    v_cvt_pk_bf16_f32 v56, v140, v141
    v_cvt_pk_bf16_f32 v57, v142, v143
    v_cvt_pk_bf16_f32 v58, v144, v145
    v_cvt_pk_bf16_f32 v59, v146, v147
    s_waitcnt lgkmcnt(2)
    v_mfma_f32_32x32x16_bf16 v[68:83], v[44:47], v[52:55], v[68:83]
    v_exp_f32 v148, v148
    v_exp_f32 v149, v149
    v_exp_f32 v150, v150
    v_exp_f32 v151, v151
    v_mfma_f32_32x32x16_bf16 v[68:83], v[48:51], v[56:59], v[68:83]
    v_exp_f32 v152, v152
    v_exp_f32 v153, v153
    v_exp_f32 v154, v154
    v_exp_f32 v155, v155
    v_exp_f32 v156, v156
    v_exp_f32 v157, v157
    v_exp_f32 v158, v158
    v_exp_f32 v159, v159
    v_cvt_pk_bf16_f32 v60, v148, v149
    v_cvt_pk_bf16_f32 v61, v150, v151
    v_cvt_pk_bf16_f32 v62, v152, v153
    v_cvt_pk_bf16_f32 v63, v154, v155
    s_nop 1
    v_mfma_f32_32x32x16_bf16 v[84:99], v[44:47], v[60:63], v[84:99]
    v_exp_f32 v160, v160
    v_exp_f32 v161, v161
    v_exp_f32 v162, v162
    v_exp_f32 v163, v163
    v_cvt_pk_bf16_f32 v64, v156, v157
    v_cvt_pk_bf16_f32 v65, v158, v159
    v_cvt_pk_bf16_f32 v66, v160, v161
    v_cvt_pk_bf16_f32 v67, v162, v163
    ds_read_b128 v[36:39], v173 offset:2048
    ds_read_b128 v[40:43], v173 offset:3072
    v_mfma_f32_32x32x16_bf16 v[84:99], v[48:51], v[64:67], v[84:99]
    s_mov_b32 s46, s43
    s_mov_b32 s43, s44
    s_mov_b32 s44, s45
    s_mov_b32 s45, s46
    v_add_u32 v172, s43, v2
    v_add_u32 v173, s44, v2
    s_add_u32 s42, s42, 1
    s_cmp_lt_u32 s42, 16
    s_cbranch_scc1 att_loop_9
    s_mov_b32 s54, 0x71800000
    v_cmp_nlt_f32 vcc, v78, s54
    s_nop 0
    v_cmp_nlt_f32 s[58:59], v94, s54
    s_nop 0
    s_or_b64 vcc, vcc, s[58:59]
    s_cmp_lg_u64 vcc, 0
    s_cselect_b32 s55, 1, 0
    v_mov_b32 v168, s55
    s_lshl_b32 s56, s28, 2
    s_add_u32 s56, s56, 0xc000
    v_mov_b32 v169, s56
    ds_write_b32 v169, v168
    s_waitcnt lgkmcnt(0)
    s_barrier
    v_mov_b32 v169, 0xc000
    ds_read_b128 v[176:179], v169
    s_waitcnt lgkmcnt(0)
    v_or_b32 v168, v176, v177
    v_or3_b32 v168, v168, v178, v179
    s_nop 0
    v_readfirstlane_b32 s55, v168
    s_nop 0
    s_cmp_lg_u32 s55, 0
    s_cbranch_scc1 att_safe_7
att_epi_8:
    s_waitcnt lgkmcnt(0)
    v_and_b32 v168, 15, v1
    v_lshlrev_b32 v168, 4, v168
    v_bfe_u32 v169, v1, 4, 1
    s_mov_b32 s47, 0x28800
    v_mul_lo_u32 v169, v169, s47
    v_add_u32 v168, v168, v169
    v_lshrrev_b32 v169, 5, v1
    v_lshlrev_b32 v169, 2, v169
    s_mul_i32 s48, s30, 18
    s_add_u32 s48, s48, 0x1200
    v_add_u32 v169, s48, v169
    v_add_u32 v170, 0, v169
    v_lshrrev_b32 v171, 3, v170
    v_lshl_add_u32 v174, v171, 8, v168
    v_and_b32 v170, 7, v170
    v_lshl_add_u32 v174, v170, 1, v174
    v_add_u32 v170, 2, v169
    v_lshrrev_b32 v171, 3, v170
    v_lshl_add_u32 v175, v171, 8, v168
    v_and_b32 v170, 7, v170
    v_lshl_add_u32 v175, v170, 1, v175
    v_add_u32 v170, 8, v169
    v_lshrrev_b32 v171, 3, v170
    v_lshl_add_u32 v176, v171, 8, v168
    v_and_b32 v170, 7, v170
    v_lshl_add_u32 v176, v170, 1, v176
    v_add_u32 v170, 10, v169
    v_lshrrev_b32 v171, 3, v170
    v_lshl_add_u32 v177, v171, 8, v168
    v_and_b32 v170, 7, v170
    v_lshl_add_u32 v177, v170, 1, v177
    v_add_u32 v170, 16, v169
    v_lshrrev_b32 v171, 3, v170
    v_lshl_add_u32 v178, v171, 8, v168
    v_and_b32 v170, 7, v170
    v_lshl_add_u32 v178, v170, 1, v178
    s_mul_i32 s48, s29, 0xa2000
    s_add_u32 s48, s48, 0x600000
    s_add_u32 s49, s48, 0x51000
    v_mov_b32 v168, v78
    v_mov_b32 v169, v78
    s_nop 1
    v_permlane32_swap_b32 v168, v169
    v_rcp_f32 v168, v168
    s_nop 0
    v_mul_f32 v68, v68, v168
    v_mul_f32 v69, v69, v168
    v_mul_f32 v70, v70, v168
    v_mul_f32 v71, v71, v168
    v_mul_f32 v72, v72, v168
    v_mul_f32 v73, v73, v168
    v_mul_f32 v74, v74, v168
    v_mul_f32 v75, v75, v168
    v_mul_f32 v76, v76, v168
    v_mul_f32 v77, v77, v168
    v_cvt_pk_bf16_f32 v52, v68, v69
    v_cvt_pk_bf16_f32 v53, v70, v71
    v_cvt_pk_bf16_f32 v54, v72, v73
    v_cvt_pk_bf16_f32 v55, v74, v75
    v_cvt_pk_bf16_f32 v56, v76, v77
    buffer_store_dword v52, v174, s[16:19], s48 offen
    buffer_store_dword v53, v175, s[16:19], s48 offen
    buffer_store_dword v54, v176, s[16:19], s48 offen
    buffer_store_dword v55, v177, s[16:19], s48 offen
    v_mov_b32 v168, v94
    v_mov_b32 v169, v94
    s_nop 1
    v_permlane32_swap_b32 v168, v169
    v_rcp_f32 v168, v168
    s_nop 0
    v_mul_f32 v84, v84, v168
    v_mul_f32 v85, v85, v168
    v_mul_f32 v86, v86, v168
    v_mul_f32 v87, v87, v168
    v_mul_f32 v88, v88, v168
    v_mul_f32 v89, v89, v168
    v_mul_f32 v90, v90, v168
    v_mul_f32 v91, v91, v168
    v_mul_f32 v92, v92, v168
    v_mul_f32 v93, v93, v168
    v_cvt_pk_bf16_f32 v60, v84, v85
    v_cvt_pk_bf16_f32 v61, v86, v87
    v_cvt_pk_bf16_f32 v62, v88, v89
    v_cvt_pk_bf16_f32 v63, v90, v91
    v_cvt_pk_bf16_f32 v64, v92, v93
    buffer_store_dword v60, v174, s[16:19], s49 offen
    buffer_store_dword v61, v175, s[16:19], s49 offen
    buffer_store_dword v62, v176, s[16:19], s49 offen
    buffer_store_dword v63, v177, s[16:19], s49 offen
    s_mov_b32 exec_hi, 0
    buffer_store_dword v56, v178, s[16:19], s48 offen
    buffer_store_dword v64, v178, s[16:19], s49 offen
    s_mov_b64 exec, -1
    s_waitcnt vmcnt(0) lgkmcnt(0)
    s_endpgm
att_safe_7:
    s_add_u32 s32, s33, 0x480000
    s_mov_b32 s35, 0
    s_add_u32 m0, s35, s33
    s_nop 0
    buffer_load_dwordx4 v2, s[16:19], s32 offen offset:0 lds
    s_add_u32 m0, s35, s33
    s_nop 0
    buffer_load_dwordx4 v2, s[16:19], s32 offen offset:1024 lds
    s_add_u32 m0, s35, s33
    s_nop 0
    buffer_load_dwordx4 v2, s[16:19], s32 offen offset:2048 lds
    s_add_u32 m0, s35, s33
    s_nop 0
    buffer_load_dwordx4 v2, s[16:19], s32 offen offset:3072 lds
    s_add_u32 s32, s32, 0x4000
    s_mov_b32 s35, 0x4000
    s_add_u32 m0, s35, s33
    s_nop 0
    buffer_load_dwordx4 v2, s[16:19], s32 offen offset:0 lds
    s_add_u32 m0, s35, s33
    s_nop 0
    buffer_load_dwordx4 v2, s[16:19], s32 offen offset:1024 lds
    s_add_u32 m0, s35, s33
    s_nop 0
    buffer_load_dwordx4 v2, s[16:19], s32 offen offset:2048 lds
    s_add_u32 m0, s35, s33
    s_nop 0
    buffer_load_dwordx4 v2, s[16:19], s32 offen offset:3072 lds
    s_add_u32 s32, s32, 0x4000
    v_mov_b32 v68, 0
    v_mov_b32 v69, 0
    v_mov_b32 v70, 0
    v_mov_b32 v71, 0
    v_mov_b32 v72, 0
    v_mov_b32 v73, 0
    v_mov_b32 v74, 0
    v_mov_b32 v75, 0
    v_mov_b32 v76, 0
    v_mov_b32 v77, 0
    v_mov_b32 v78, 0
    v_mov_b32 v79, 0
    v_mov_b32 v80, 0
    v_mov_b32 v81, 0
    v_mov_b32 v82, 0
    v_mov_b32 v83, 0
    v_mov_b32 v164, 0
    v_mov_b32 v9, 0
    v_mov_b32 v84, 0
    v_mov_b32 v85, 0
    v_mov_b32 v86, 0
    v_mov_b32 v87, 0
    v_mov_b32 v88, 0
    v_mov_b32 v89, 0
    v_mov_b32 v90, 0
    v_mov_b32 v91, 0
    v_mov_b32 v92, 0
    v_mov_b32 v93, 0
    v_mov_b32 v94, 0
    v_mov_b32 v95, 0
    v_mov_b32 v96, 0
    v_mov_b32 v97, 0
    v_mov_b32 v98, 0
    v_mov_b32 v99, 0
    v_mov_b32 v165, 0
    v_mov_b32 v17, 0
    s_mov_b32 s40, 0xff800000
    s_mov_b32 s41, 0xff800000
    s_mov_b32 s53, 0x4b800000
    s_waitcnt vmcnt(0)
    s_barrier
    v_mov_b32 v172, v2
    v_add_u32 v173, 0x4000, v2
    s_mov_b32 s43, 0
    s_mov_b32 s44, 0x4000
    s_mov_b32 s45, 0x8000
    ds_read_b128 v[20:23], v172 offset:0
    ds_read_b128 v[24:27], v172 offset:1024
    ds_read_b128 v[28:31], v172 offset:4096
    ds_read_b128 v[32:35], v172 offset:5120
    ds_read_b128 v[36:39], v172 offset:2048
    ds_read_b128 v[40:43], v172 offset:3072
    s_waitcnt lgkmcnt(0)
    v_mfma_f32_32x32x16_bf16 v[100:115], v[20:23], v[4:7], 0
    v_mfma_f32_32x32x16_bf16 v[100:115], v[24:27], v[8:11], v[100:115]
    v_mfma_f32_32x32x16_bf16 v[116:131], v[20:23], v[12:15], 0
    v_mfma_f32_32x32x16_bf16 v[116:131], v[24:27], v[16:19], v[116:131]
    s_mov_b32 s42, 0
att_loop_13:
    s_waitcnt vmcnt(0) lgkmcnt(0)
    s_barrier
    s_cmp_lt_u32 s42, 14
    s_cbranch_scc0 att_nd_14
    s_add_u32 m0, s45, s33
    s_nop 0
    buffer_load_dwordx4 v2, s[16:19], s32 offen offset:0 lds
    s_add_u32 m0, s45, s33
    s_nop 0
    buffer_load_dwordx4 v2, s[16:19], s32 offen offset:1024 lds
    s_add_u32 m0, s45, s33
    s_nop 0
    buffer_load_dwordx4 v2, s[16:19], s32 offen offset:2048 lds
    s_add_u32 m0, s45, s33
    s_nop 0
    buffer_load_dwordx4 v2, s[16:19], s32 offen offset:3072 lds
    s_add_u32 s32, s32, 0x4000
att_nd_14:
    s_nop 4
    v_max3_f32 v166, v100, v101, v102
    s_nop 3
    v_max3_f32 v166, v166, v103, v104
    s_nop 2
    v_max3_f32 v166, v166, v105, v106
    s_nop 1
    v_max3_f32 v166, v166, v107, v108
    s_nop 0
    v_max3_f32 v166, v166, v109, v110
    v_max3_f32 v166, v166, v111, v112
    v_max3_f32 v166, v166, v113, v114
    v_max_f32 v166, v166, v115
    v_max3_f32 v167, v116, v117, v118
    v_max3_f32 v167, v167, v119, v120
    v_max3_f32 v167, v167, v121, v122
    v_max3_f32 v167, v167, v123, v124
    v_max3_f32 v167, v167, v125, v126
    v_max3_f32 v167, v167, v127, v128
    v_max3_f32 v167, v167, v129, v130
    v_max_f32 v167, v167, v131
    v_max_f32 v168, v166, v167
    v_cmp_lt_f32 vcc, s40, v168
    s_cbranch_vccnz att_resc_15
att_back_16:
    v_exp_f32 v100, v100
    v_exp_f32 v101, v101
    v_exp_f32 v102, v102
    v_exp_f32 v103, v103
    v_mfma_f32_32x32x16_bf16 v[132:147], v[28:31], v[4:7], 0
    v_exp_f32 v104, v104
    v_exp_f32 v105, v105
    v_exp_f32 v106, v106
    v_exp_f32 v107, v107
    v_mfma_f32_32x32x16_bf16 v[132:147], v[32:35], v[8:11], v[132:147]
    v_exp_f32 v108, v108
    v_exp_f32 v109, v109
    v_exp_f32 v110, v110
    v_exp_f32 v111, v111
    v_mfma_f32_32x32x16_bf16 v[148:163], v[28:31], v[12:15], 0
    v_exp_f32 v112, v112
    v_exp_f32 v113, v113
    v_exp_f32 v114, v114
    v_exp_f32 v115, v115
    v_mfma_f32_32x32x16_bf16 v[148:163], v[32:35], v[16:19], v[148:163]
    ds_read_b128 v[20:23], v172 offset:8192
    ds_read_b128 v[24:27], v172 offset:9216
    v_cvt_pk_bf16_f32 v52, v100, v101
    v_cvt_pk_bf16_f32 v53, v102, v103
    v_cvt_pk_bf16_f32 v54, v104, v105
    v_cvt_pk_bf16_f32 v55, v106, v107
    v_cvt_pk_bf16_f32 v56, v108, v109
    v_cvt_pk_bf16_f32 v57, v110, v111
    v_cvt_pk_bf16_f32 v58, v112, v113
    v_cvt_pk_bf16_f32 v59, v114, v115
    s_waitcnt lgkmcnt(2)
    v_mfma_f32_32x32x16_bf16 v[68:83], v[36:39], v[52:55], v[68:83]
    v_exp_f32 v116, v116
    v_exp_f32 v117, v117
    v_exp_f32 v118, v118
    v_exp_f32 v119, v119
    v_mfma_f32_32x32x16_bf16 v[68:83], v[40:43], v[56:59], v[68:83]
    v_exp_f32 v120, v120
    v_exp_f32 v121, v121
    v_exp_f32 v122, v122
    v_exp_f32 v123, v123
    v_exp_f32 v124, v124
    v_exp_f32 v125, v125
    v_exp_f32 v126, v126
    v_exp_f32 v127, v127
    v_cvt_pk_bf16_f32 v60, v116, v117
    v_cvt_pk_bf16_f32 v61, v118, v119
    v_cvt_pk_bf16_f32 v62, v120, v121
    v_cvt_pk_bf16_f32 v63, v122, v123
    s_nop 1
    v_mfma_f32_32x32x16_bf16 v[84:99], v[36:39], v[60:63], v[84:99]
    v_exp_f32 v128, v128
    v_exp_f32 v129, v129
    v_exp_f32 v130, v130
    v_exp_f32 v131, v131
    v_cvt_pk_bf16_f32 v64, v124, v125
    v_cvt_pk_bf16_f32 v65, v126, v127
    v_cvt_pk_bf16_f32 v66, v128, v129
    v_cvt_pk_bf16_f32 v67, v130, v131
    ds_read_b128 v[44:47], v172 offset:6144
    ds_read_b128 v[48:51], v172 offset:7168
    v_mfma_f32_32x32x16_bf16 v[84:99], v[40:43], v[64:67], v[84:99]
    v_max3_f32 v166, v132, v133, v134
    v_max3_f32 v166, v166, v135, v136
    v_max3_f32 v166, v166, v137, v138
    v_max3_f32 v166, v166, v139, v140
    v_max3_f32 v166, v166, v141, v142
    v_max3_f32 v166, v166, v143, v144
    v_max3_f32 v166, v166, v145, v146
    v_max_f32 v166, v166, v147
    v_max3_f32 v167, v148, v149, v150
    v_max3_f32 v167, v167, v151, v152
    v_max3_f32 v167, v167, v153, v154
    v_max3_f32 v167, v167, v155, v156
    v_max3_f32 v167, v167, v157, v158
    v_max3_f32 v167, v167, v159, v160
    v_max3_f32 v167, v167, v161, v162
    v_max_f32 v167, v167, v163
    v_max_f32 v168, v166, v167
    v_cmp_lt_f32 vcc, s40, v168
    s_cbranch_vccnz att_resc_17
att_back_18:
    s_waitcnt lgkmcnt(2)
    v_exp_f32 v132, v132
    v_exp_f32 v133, v133
    v_exp_f32 v134, v134
    v_exp_f32 v135, v135
    v_mfma_f32_32x32x16_bf16 v[100:115], v[20:23], v[4:7], 0
    v_exp_f32 v136, v136
    v_exp_f32 v137, v137
    v_exp_f32 v138, v138
    v_exp_f32 v139, v139
    v_mfma_f32_32x32x16_bf16 v[100:115], v[24:27], v[8:11], v[100:115]
    v_exp_f32 v140, v140
    v_exp_f32 v141, v141
    v_exp_f32 v142, v142
    v_exp_f32 v143, v143
    v_mfma_f32_32x32x16_bf16 v[116:131], v[20:23], v[12:15], 0
    v_exp_f32 v144, v144
    v_exp_f32 v145, v145
    v_exp_f32 v146, v146
    v_exp_f32 v147, v147
    v_mfma_f32_32x32x16_bf16 v[116:131], v[24:27], v[16:19], v[116:131]
    ds_read_b128 v[28:31], v172 offset:12288
    ds_read_b128 v[32:35], v172 offset:13312
    v_cvt_pk_bf16_f32 v52, v132, v133
    v_cvt_pk_bf16_f32 v53, v134, v135
    v_cvt_pk_bf16_f32 v54, v136, v137
    v_cvt_pk_bf16_f32 v55, v138, v139
    v_cvt_pk_bf16_f32 v56, v140, v141
    v_cvt_pk_bf16_f32 v57, v142, v143
    v_cvt_pk_bf16_f32 v58, v144, v145
    v_cvt_pk_bf16_f32 v59, v146, v147
    s_waitcnt lgkmcnt(2)
    v_mfma_f32_32x32x16_bf16 v[68:83], v[44:47], v[52:55], v[68:83]
    v_exp_f32 v148, v148
    v_exp_f32 v149, v149
    v_exp_f32 v150, v150
    v_exp_f32 v151, v151
    v_mfma_f32_32x32x16_bf16 v[68:83], v[48:51], v[56:59], v[68:83]
    v_exp_f32 v152, v152
    v_exp_f32 v153, v153
    v_exp_f32 v154, v154
    v_exp_f32 v155, v155
    v_exp_f32 v156, v156
    v_exp_f32 v157, v157
    v_exp_f32 v158, v158
    v_exp_f32 v159, v159
    v_cvt_pk_bf16_f32 v60, v148, v149
    v_cvt_pk_bf16_f32 v61, v150, v151
    v_cvt_pk_bf16_f32 v62, v152, v153
    v_cvt_pk_bf16_f32 v63, v154, v155
    s_nop 1
    v_mfma_f32_32x32x16_bf16 v[84:99], v[44:47], v[60:63], v[84:99]
    v_exp_f32 v160, v160
    v_exp_f32 v161, v161
    v_exp_f32 v162, v162
    v_exp_f32 v163, v163
    v_cvt_pk_bf16_f32 v64, v156, v157
    v_cvt_pk_bf16_f32 v65, v158, v159
    v_cvt_pk_bf16_f32 v66, v160, v161
    v_cvt_pk_bf16_f32 v67, v162, v163
    ds_read_b128 v[36:39], v172 offset:10240
    ds_read_b128 v[40:43], v172 offset:11264
    v_mfma_f32_32x32x16_bf16 v[84:99], v[48:51], v[64:67], v[84:99]
    v_max3_f32 v166, v100, v101, v102
    v_max3_f32 v166, v166, v103, v104
    v_max3_f32 v166, v166, v105, v106
    v_max3_f32 v166, v166, v107, v108
    v_max3_f32 v166, v166, v109, v110
    v_max3_f32 v166, v166, v111, v112
    v_max3_f32 v166, v166, v113, v114
    v_max_f32 v166, v166, v115
    v_max3_f32 v167, v116, v117, v118
    v_max3_f32 v167, v167, v119, v120
    v_max3_f32 v167, v167, v121, v122
    v_max3_f32 v167, v167, v123, v124
    v_max3_f32 v167, v167, v125, v126
    v_max3_f32 v167, v167, v127, v128
    v_max3_f32 v167, v167, v129, v130
    v_max_f32 v167, v167, v131
    v_max_f32 v168, v166, v167
    v_cmp_lt_f32 vcc, s40, v168
    s_cbranch_vccnz att_resc_19
att_back_20:
    s_waitcnt lgkmcnt(2)
    v_exp_f32 v100, v100
    v_exp_f32 v101, v101
    v_exp_f32 v102, v102
    v_exp_f32 v103, v103
    v_mfma_f32_32x32x16_bf16 v[132:147], v[28:31], v[4:7], 0
    v_exp_f32 v104, v104
    v_exp_f32 v105, v105
    v_exp_f32 v106, v106
    v_exp_f32 v107, v107
    v_mfma_f32_32x32x16_bf16 v[132:147], v[32:35], v[8:11], v[132:147]
    v_exp_f32 v108, v108
    v_exp_f32 v109, v109
    v_exp_f32 v110, v110
    v_exp_f32 v111, v111
    v_mfma_f32_32x32x16_bf16 v[148:163], v[28:31], v[12:15], 0
    v_exp_f32 v112, v112
    v_exp_f32 v113, v113
    v_exp_f32 v114, v114
    v_exp_f32 v115, v115
    v_mfma_f32_32x32x16_bf16 v[148:163], v[32:35], v[16:19], v[148:163]
    ds_read_b128 v[20:23], v173 offset:0
    ds_read_b128 v[24:27], v173 offset:1024
    v_cvt_pk_bf16_f32 v52, v100, v101
    v_cvt_pk_bf16_f32 v53, v102, v103
    v_cvt_pk_bf16_f32 v54, v104, v105
    v_cvt_pk_bf16_f32 v55, v106, v107
    v_cvt_pk_bf16_f32 v56, v108, v109
    v_cvt_pk_bf16_f32 v57, v110, v111
    v_cvt_pk_bf16_f32 v58, v112, v113
    v_cvt_pk_bf16_f32 v59, v114, v115
    s_waitcnt lgkmcnt(2)
    v_mfma_f32_32x32x16_bf16 v[68:83], v[36:39], v[52:55], v[68:83]
    v_exp_f32 v116, v116
    v_exp_f32 v117, v117
    v_exp_f32 v118, v118
    v_exp_f32 v119, v119
    v_mfma_f32_32x32x16_bf16 v[68:83], v[40:43], v[56:59], v[68:83]
    v_exp_f32 v120, v120
    v_exp_f32 v121, v121
    v_exp_f32 v122, v122
    v_exp_f32 v123, v123
    v_exp_f32 v124, v124
    v_exp_f32 v125, v125
    v_exp_f32 v126, v126
    v_exp_f32 v127, v127
    v_cvt_pk_bf16_f32 v60, v116, v117
    v_cvt_pk_bf16_f32 v61, v118, v119
    v_cvt_pk_bf16_f32 v62, v120, v121
    v_cvt_pk_bf16_f32 v63, v122, v123
    s_nop 1
    v_mfma_f32_32x32x16_bf16 v[84:99], v[36:39], v[60:63], v[84:99]
    v_exp_f32 v128, v128
    v_exp_f32 v129, v129
    v_exp_f32 v130, v130
    v_exp_f32 v131, v131
    v_cvt_pk_bf16_f32 v64, v124, v125
    v_cvt_pk_bf16_f32 v65, v126, v127
    v_cvt_pk_bf16_f32 v66, v128, v129
    v_cvt_pk_bf16_f32 v67, v130, v131
    ds_read_b128 v[44:47], v172 offset:14336
    ds_read_b128 v[48:51], v172 offset:15360
    v_mfma_f32_32x32x16_bf16 v[84:99], v[40:43], v[64:67], v[84:99]
    v_max3_f32 v166, v132, v133, v134
    v_max3_f32 v166, v166, v135, v136
    v_max3_f32 v166, v166, v137, v138
    v_max3_f32 v166, v166, v139, v140
    v_max3_f32 v166, v166, v141, v142
    v_max3_f32 v166, v166, v143, v144
    v_max3_f32 v166, v166, v145, v146
    v_max_f32 v166, v166, v147
    v_max3_f32 v167, v148, v149, v150
    v_max3_f32 v167, v167, v151, v152
    v_max3_f32 v167, v167, v153, v154
    v_max3_f32 v167, v167, v155, v156
    v_max3_f32 v167, v167, v157, v158
    v_max3_f32 v167, v167, v159, v160
    v_max3_f32 v167, v167, v161, v162
    v_max_f32 v167, v167, v163
    v_max_f32 v168, v166, v167
    v_cmp_lt_f32 vcc, s40, v168
    s_cbranch_vccnz att_resc_21
att_back_22:
    s_waitcnt lgkmcnt(2)
    v_exp_f32 v132, v132
    v_exp_f32 v133, v133
    v_exp_f32 v134, v134
    v_exp_f32 v135, v135
    v_mfma_f32_32x32x16_bf16 v[100:115], v[20:23], v[4:7], 0
    v_exp_f32 v136, v136
    v_exp_f32 v137, v137
    v_exp_f32 v138, v138
    v_exp_f32 v139, v139
    v_mfma_f32_32x32x16_bf16 v[100:115], v[24:27], v[8:11], v[100:115]
    v_exp_f32 v140, v140
    v_exp_f32 v141, v141
    v_exp_f32 v142, v142
    v_exp_f32 v143, v143
    v_mfma_f32_32x32x16_bf16 v[116:131], v[20:23], v[12:15], 0
    v_exp_f32 v144, v144
    v_exp_f32 v145, v145
    v_exp_f32 v146, v146
    v_exp_f32 v147, v147
    v_mfma_f32_32x32x16_bf16 v[116:131], v[24:27], v[16:19], v[116:131]
    ds_read_b128 v[28:31], v173 offset:4096
    ds_read_b128 v[32:35], v173 offset:5120
    v_cvt_pk_bf16_f32 v52, v132, v133
    v_cvt_pk_bf16_f32 v53, v134, v135
    v_cvt_pk_bf16_f32 v54, v136, v137
    v_cvt_pk_bf16_f32 v55, v138, v139
    v_cvt_pk_bf16_f32 v56, v140, v141
    v_cvt_pk_bf16_f32 v57, v142, v143
    v_cvt_pk_bf16_f32 v58, v144, v145
    v_cvt_pk_bf16_f32 v59, v146, v147
    s_waitcnt lgkmcnt(2)
    v_mfma_f32_32x32x16_bf16 v[68:83], v[44:47], v[52:55], v[68:83]
    v_exp_f32 v148, v148
    v_exp_f32 v149, v149
    v_exp_f32 v150, v150
    v_exp_f32 v151, v151
    v_mfma_f32_32x32x16_bf16 v[68:83], v[48:51], v[56:59], v[68:83]
    v_exp_f32 v152, v152
    v_exp_f32 v153, v153
    v_exp_f32 v154, v154
    v_exp_f32 v155, v155
    v_exp_f32 v156, v156
    v_exp_f32 v157, v157
    v_exp_f32 v158, v158
    v_exp_f32 v159, v159
    v_cvt_pk_bf16_f32 v60, v148, v149
    v_cvt_pk_bf16_f32 v61, v150, v151
    v_cvt_pk_bf16_f32 v62, v152, v153
    v_cvt_pk_bf16_f32 v63, v154, v155
    s_nop 1
    v_mfma_f32_32x32x16_bf16 v[84:99], v[44:47], v[60:63], v[84:99]
    v_exp_f32 v160, v160
    v_exp_f32 v161, v161
    v_exp_f32 v162, v162
    v_exp_f32 v163, v163
    v_cvt_pk_bf16_f32 v64, v156, v157
    v_cvt_pk_bf16_f32 v65, v158, v159
    v_cvt_pk_bf16_f32 v66, v160, v161
    v_cvt_pk_bf16_f32 v67, v162, v163
    ds_read_b128 v[36:39], v173 offset:2048
    ds_read_b128 v[40:43], v173 offset:3072
    v_mfma_f32_32x32x16_bf16 v[84:99], v[48:51], v[64:67], v[84:99]
    s_mov_b32 s46, s43
    s_mov_b32 s43, s44
    s_mov_b32 s44, s45
    s_mov_b32 s45, s46
    v_add_u32 v172, s43, v2
    v_add_u32 v173, s44, v2
    s_add_u32 s42, s42, 1
    s_cmp_lt_u32 s42, 16
    s_cbranch_scc1 att_loop_13
    s_branch att_epi_8
att_resc_11:
    v_mov_b32 v168, v78
    v_mov_b32 v169, v78
    s_nop 1
    v_permlane32_swap_b32 v168, v169
    v_log_f32 v168, v168
    s_nop 0
    v_max_f32 v168, 0, v168
    v_add_f32 v168, v164, v168
    v_and_b32 v168, 0xffff0000, v168
    v_sub_f32 v169, v168, v164
    v_mov_b32 v164, v168
    v_xor_b32 v170, 0x80000000, v168
    v_lshrrev_b32 v9, 16, v170
    v_sub_f32 v100, v100, v169
    v_sub_f32 v101, v101, v169
    v_sub_f32 v102, v102, v169
    v_sub_f32 v103, v103, v169
    v_sub_f32 v104, v104, v169
    v_sub_f32 v105, v105, v169
    v_sub_f32 v106, v106, v169
    v_sub_f32 v107, v107, v169
    v_sub_f32 v108, v108, v169
    v_sub_f32 v109, v109, v169
    v_sub_f32 v110, v110, v169
    v_sub_f32 v111, v111, v169
    v_sub_f32 v112, v112, v169
    v_sub_f32 v113, v113, v169
    v_sub_f32 v114, v114, v169
    v_sub_f32 v115, v115, v169
    v_sub_f32 v170, 0, v169
    v_min_f32 v170, 0, v170
    v_exp_f32 v170, v170
    s_nop 0
    v_mul_f32 v68, v68, v170
    v_mul_f32 v69, v69, v170
    v_mul_f32 v70, v70, v170
    v_mul_f32 v71, v71, v170
    v_mul_f32 v72, v72, v170
    v_mul_f32 v73, v73, v170
    v_mul_f32 v74, v74, v170
    v_mul_f32 v75, v75, v170
    v_mul_f32 v76, v76, v170
    v_mul_f32 v77, v77, v170
    v_mul_f32 v78, v78, v170
    v_mul_f32 v79, v79, v170
    v_mul_f32 v80, v80, v170
    v_mul_f32 v81, v81, v170
    v_mul_f32 v82, v82, v170
    v_mul_f32 v83, v83, v170
    v_mov_b32 v168, v94
    v_mov_b32 v169, v94
    s_nop 1
    v_permlane32_swap_b32 v168, v169
    v_log_f32 v168, v168
    s_nop 0
    v_max_f32 v168, 0, v168
    v_add_f32 v168, v165, v168
    v_and_b32 v168, 0xffff0000, v168
    v_sub_f32 v169, v168, v165
    v_mov_b32 v165, v168
    v_xor_b32 v170, 0x80000000, v168
    v_lshrrev_b32 v17, 16, v170
    v_sub_f32 v116, v116, v169
    v_sub_f32 v117, v117, v169
    v_sub_f32 v118, v118, v169
    v_sub_f32 v119, v119, v169
    v_sub_f32 v120, v120, v169
    v_sub_f32 v121, v121, v169
    v_sub_f32 v122, v122, v169
    v_sub_f32 v123, v123, v169
    v_sub_f32 v124, v124, v169
    v_sub_f32 v125, v125, v169
    v_sub_f32 v126, v126, v169
    v_sub_f32 v127, v127, v169
    v_sub_f32 v128, v128, v169
    v_sub_f32 v129, v129, v169
    v_sub_f32 v130, v130, v169
    v_sub_f32 v131, v131, v169
    v_sub_f32 v170, 0, v169
    v_min_f32 v170, 0, v170
    v_exp_f32 v170, v170
    s_nop 0
    v_mul_f32 v84, v84, v170
    v_mul_f32 v85, v85, v170
    v_mul_f32 v86, v86, v170
    v_mul_f32 v87, v87, v170
    v_mul_f32 v88, v88, v170
    v_mul_f32 v89, v89, v170
    v_mul_f32 v90, v90, v170
    v_mul_f32 v91, v91, v170
    v_mul_f32 v92, v92, v170
    v_mul_f32 v93, v93, v170
    v_mul_f32 v94, v94, v170
    v_mul_f32 v95, v95, v170
    v_mul_f32 v96, v96, v170
    v_mul_f32 v97, v97, v170
    v_mul_f32 v98, v98, v170
    v_mul_f32 v99, v99, v170
    s_branch att_back_12
att_resc_15:
    v_mov_b32 v168, v166
    v_mov_b32 v169, v166
    s_nop 1
    v_permlane32_swap_b32 v168, v169
    v_max_f32 v168, v168, v169
    v_max_f32 v168, s41, v168
    v_add_f32 v168, v164, v168
    v_and_b32 v168, 0xffff0000, v168
    v_sub_f32 v169, v168, v164
    v_mov_b32 v164, v168
    v_xor_b32 v170, 0x80000000, v168
    v_lshrrev_b32 v9, 16, v170
    v_sub_f32 v100, v100, v169
    v_sub_f32 v101, v101, v169
    v_sub_f32 v102, v102, v169
    v_sub_f32 v103, v103, v169
    v_sub_f32 v104, v104, v169
    v_sub_f32 v105, v105, v169
    v_sub_f32 v106, v106, v169
    v_sub_f32 v107, v107, v169
    v_sub_f32 v108, v108, v169
    v_sub_f32 v109, v109, v169
    v_sub_f32 v110, v110, v169
    v_sub_f32 v111, v111, v169
    v_sub_f32 v112, v112, v169
    v_sub_f32 v113, v113, v169
    v_sub_f32 v114, v114, v169
    v_sub_f32 v115, v115, v169
    v_sub_f32 v170, 0, v169
    v_min_f32 v170, 0, v170
    v_exp_f32 v170, v170
    s_nop 0
    v_mul_f32 v68, v68, v170
    v_mul_f32 v69, v69, v170
    v_mul_f32 v70, v70, v170
    v_mul_f32 v71, v71, v170
    v_mul_f32 v72, v72, v170
    v_mul_f32 v73, v73, v170
    v_mul_f32 v74, v74, v170
    v_mul_f32 v75, v75, v170
    v_mul_f32 v76, v76, v170
    v_mul_f32 v77, v77, v170
    v_mul_f32 v78, v78, v170
    v_mul_f32 v79, v79, v170
    v_mul_f32 v80, v80, v170
    v_mul_f32 v81, v81, v170
    v_mul_f32 v82, v82, v170
    v_mul_f32 v83, v83, v170
    v_mov_b32 v168, v167
    v_mov_b32 v169, v167
    s_nop 1
    v_permlane32_swap_b32 v168, v169
    v_max_f32 v168, v168, v169
    v_max_f32 v168, s41, v168
    v_add_f32 v168, v165, v168
    v_and_b32 v168, 0xffff0000, v168
    v_sub_f32 v169, v168, v165
    v_mov_b32 v165, v168
    v_xor_b32 v170, 0x80000000, v168
    v_lshrrev_b32 v17, 16, v170
    v_sub_f32 v116, v116, v169
    v_sub_f32 v117, v117, v169
    v_sub_f32 v118, v118, v169
    v_sub_f32 v119, v119, v169
    v_sub_f32 v120, v120, v169
    v_sub_f32 v121, v121, v169
    v_sub_f32 v122, v122, v169
    v_sub_f32 v123, v123, v169
    v_sub_f32 v124, v124, v169
    v_sub_f32 v125, v125, v169
    v_sub_f32 v126, v126, v169
    v_sub_f32 v127, v127, v169
    v_sub_f32 v128, v128, v169
    v_sub_f32 v129, v129, v169
    v_sub_f32 v130, v130, v169
    v_sub_f32 v131, v131, v169
    v_sub_f32 v170, 0, v169
    v_min_f32 v170, 0, v170
    v_exp_f32 v170, v170
    s_nop 0
    v_mul_f32 v84, v84, v170
    v_mul_f32 v85, v85, v170
    v_mul_f32 v86, v86, v170
    v_mul_f32 v87, v87, v170
    v_mul_f32 v88, v88, v170
    v_mul_f32 v89, v89, v170
    v_mul_f32 v90, v90, v170
    v_mul_f32 v91, v91, v170
    v_mul_f32 v92, v92, v170
    v_mul_f32 v93, v93, v170
    v_mul_f32 v94, v94, v170
    v_mul_f32 v95, v95, v170
    v_mul_f32 v96, v96, v170
    v_mul_f32 v97, v97, v170
    v_mul_f32 v98, v98, v170
    v_mul_f32 v99, v99, v170
    s_mov_b32 s40, 0x41000000
    s_mov_b32 s41, 0
    s_branch att_back_16
att_resc_17:
    v_mov_b32 v168, v166
    v_mov_b32 v169, v166
    s_nop 1
    v_permlane32_swap_b32 v168, v169
    v_max_f32 v168, v168, v169
    v_max_f32 v168, s41, v168
    v_add_f32 v168, v164, v168
    v_and_b32 v168, 0xffff0000, v168
    v_sub_f32 v169, v168, v164
    v_mov_b32 v164, v168
    v_xor_b32 v170, 0x80000000, v168
    v_lshrrev_b32 v9, 16, v170
    v_sub_f32 v132, v132, v169
    v_sub_f32 v133, v133, v169
    v_sub_f32 v134, v134, v169
    v_sub_f32 v135, v135, v169
    v_sub_f32 v136, v136, v169
    v_sub_f32 v137, v137, v169
    v_sub_f32 v138, v138, v169
    v_sub_f32 v139, v139, v169
    v_sub_f32 v140, v140, v169
    v_sub_f32 v141, v141, v169
    v_sub_f32 v142, v142, v169
    v_sub_f32 v143, v143, v169
    v_sub_f32 v144, v144, v169
    v_sub_f32 v145, v145, v169
    v_sub_f32 v146, v146, v169
    v_sub_f32 v147, v147, v169
    v_sub_f32 v170, 0, v169
    v_min_f32 v170, 0, v170
    v_exp_f32 v170, v170
    s_nop 0
    v_mul_f32 v68, v68, v170
    v_mul_f32 v69, v69, v170
    v_mul_f32 v70, v70, v170
    v_mul_f32 v71, v71, v170
    v_mul_f32 v72, v72, v170
    v_mul_f32 v73, v73, v170
    v_mul_f32 v74, v74, v170
    v_mul_f32 v75, v75, v170
    v_mul_f32 v76, v76, v170
    v_mul_f32 v77, v77, v170
    v_mul_f32 v78, v78, v170
    v_mul_f32 v79, v79, v170
    v_mul_f32 v80, v80, v170
    v_mul_f32 v81, v81, v170
    v_mul_f32 v82, v82, v170
    v_mul_f32 v83, v83, v170
    v_mov_b32 v168, v167
    v_mov_b32 v169, v167
    s_nop 1
    v_permlane32_swap_b32 v168, v169
    v_max_f32 v168, v168, v169
    v_max_f32 v168, s41, v168
    v_add_f32 v168, v165, v168
    v_and_b32 v168, 0xffff0000, v168
    v_sub_f32 v169, v168, v165
    v_mov_b32 v165, v168
    v_xor_b32 v170, 0x80000000, v168
    v_lshrrev_b32 v17, 16, v170
    v_sub_f32 v148, v148, v169
    v_sub_f32 v149, v149, v169
    v_sub_f32 v150, v150, v169
    v_sub_f32 v151, v151, v169
    v_sub_f32 v152, v152, v169
    v_sub_f32 v153, v153, v169
    v_sub_f32 v154, v154, v169
    v_sub_f32 v155, v155, v169
    v_sub_f32 v156, v156, v169
    v_sub_f32 v157, v157, v169
    v_sub_f32 v158, v158, v169
    v_sub_f32 v159, v159, v169
    v_sub_f32 v160, v160, v169
    v_sub_f32 v161, v161, v169
    v_sub_f32 v162, v162, v169
    v_sub_f32 v163, v163, v169
    v_sub_f32 v170, 0, v169
    v_min_f32 v170, 0, v170
    v_exp_f32 v170, v170
    s_nop 0
    v_mul_f32 v84, v84, v170
    v_mul_f32 v85, v85, v170
    v_mul_f32 v86, v86, v170
    v_mul_f32 v87, v87, v170
    v_mul_f32 v88, v88, v170
    v_mul_f32 v89, v89, v170
    v_mul_f32 v90, v90, v170
    v_mul_f32 v91, v91, v170
    v_mul_f32 v92, v92, v170
    v_mul_f32 v93, v93, v170
    v_mul_f32 v94, v94, v170
    v_mul_f32 v95, v95, v170
    v_mul_f32 v96, v96, v170
    v_mul_f32 v97, v97, v170
    v_mul_f32 v98, v98, v170
    v_mul_f32 v99, v99, v170
    s_mov_b32 s40, 0x41000000
    s_mov_b32 s41, 0
    s_branch att_back_18
att_resc_19:
    v_mov_b32 v168, v166
    v_mov_b32 v169, v166
    s_nop 1
    v_permlane32_swap_b32 v168, v169
    v_max_f32 v168, v168, v169
    v_max_f32 v168, s41, v168
    v_add_f32 v168, v164, v168
    v_and_b32 v168, 0xffff0000, v168
    v_sub_f32 v169, v168, v164
    v_mov_b32 v164, v168
    v_xor_b32 v170, 0x80000000, v168
    v_lshrrev_b32 v9, 16, v170
    v_sub_f32 v100, v100, v169
    v_sub_f32 v101, v101, v169
    v_sub_f32 v102, v102, v169
    v_sub_f32 v103, v103, v169
    v_sub_f32 v104, v104, v169
    v_sub_f32 v105, v105, v169
    v_sub_f32 v106, v106, v169
    v_sub_f32 v107, v107, v169
    v_sub_f32 v108, v108, v169
    v_sub_f32 v109, v109, v169
    v_sub_f32 v110, v110, v169
    v_sub_f32 v111, v111, v169
    v_sub_f32 v112, v112, v169
    v_sub_f32 v113, v113, v169
    v_sub_f32 v114, v114, v169
    v_sub_f32 v115, v115, v169
    v_sub_f32 v170, 0, v169
    v_min_f32 v170, 0, v170
    v_exp_f32 v170, v170
    s_nop 0
    v_mul_f32 v68, v68, v170
    v_mul_f32 v69, v69, v170
    v_mul_f32 v70, v70, v170
    v_mul_f32 v71, v71, v170
    v_mul_f32 v72, v72, v170
    v_mul_f32 v73, v73, v170
    v_mul_f32 v74, v74, v170
    v_mul_f32 v75, v75, v170
    v_mul_f32 v76, v76, v170
    v_mul_f32 v77, v77, v170
    v_mul_f32 v78, v78, v170
    v_mul_f32 v79, v79, v170
    v_mul_f32 v80, v80, v170
    v_mul_f32 v81, v81, v170
    v_mul_f32 v82, v82, v170
    v_mul_f32 v83, v83, v170
    v_mov_b32 v168, v167
    v_mov_b32 v169, v167
    s_nop 1
    v_permlane32_swap_b32 v168, v169
    v_max_f32 v168, v168, v169
    v_max_f32 v168, s41, v168
    v_add_f32 v168, v165, v168
    v_and_b32 v168, 0xffff0000, v168
    v_sub_f32 v169, v168, v165
    v_mov_b32 v165, v168
    v_xor_b32 v170, 0x80000000, v168
    v_lshrrev_b32 v17, 16, v170
    v_sub_f32 v116, v116, v169
    v_sub_f32 v117, v117, v169
    v_sub_f32 v118, v118, v169
    v_sub_f32 v119, v119, v169
    v_sub_f32 v120, v120, v169
    v_sub_f32 v121, v121, v169
    v_sub_f32 v122, v122, v169
    v_sub_f32 v123, v123, v169
    v_sub_f32 v124, v124, v169
    v_sub_f32 v125, v125, v169
    v_sub_f32 v126, v126, v169
    v_sub_f32 v127, v127, v169
    v_sub_f32 v128, v128, v169
    v_sub_f32 v129, v129, v169
    v_sub_f32 v130, v130, v169
    v_sub_f32 v131, v131, v169
    v_sub_f32 v170, 0, v169
    v_min_f32 v170, 0, v170
    v_exp_f32 v170, v170
    s_nop 0
    v_mul_f32 v84, v84, v170
    v_mul_f32 v85, v85, v170
    v_mul_f32 v86, v86, v170
    v_mul_f32 v87, v87, v170
    v_mul_f32 v88, v88, v170
    v_mul_f32 v89, v89, v170
    v_mul_f32 v90, v90, v170
    v_mul_f32 v91, v91, v170
    v_mul_f32 v92, v92, v170
    v_mul_f32 v93, v93, v170
    v_mul_f32 v94, v94, v170
    v_mul_f32 v95, v95, v170
    v_mul_f32 v96, v96, v170
    v_mul_f32 v97, v97, v170
    v_mul_f32 v98, v98, v170
    v_mul_f32 v99, v99, v170
    s_mov_b32 s40, 0x41000000
    s_mov_b32 s41, 0
    s_branch att_back_20
att_resc_21:
    v_mov_b32 v168, v166
    v_mov_b32 v169, v166
    s_nop 1
    v_permlane32_swap_b32 v168, v169
    v_max_f32 v168, v168, v169
    v_max_f32 v168, s41, v168
    v_add_f32 v168, v164, v168
    v_and_b32 v168, 0xffff0000, v168
    v_sub_f32 v169, v168, v164
    v_mov_b32 v164, v168
    v_xor_b32 v170, 0x80000000, v168
    v_lshrrev_b32 v9, 16, v170
    v_sub_f32 v132, v132, v169
    v_sub_f32 v133, v133, v169
    v_sub_f32 v134, v134, v169
    v_sub_f32 v135, v135, v169
    v_sub_f32 v136, v136, v169
    v_sub_f32 v137, v137, v169
    v_sub_f32 v138, v138, v169
    v_sub_f32 v139, v139, v169
    v_sub_f32 v140, v140, v169
    v_sub_f32 v141, v141, v169
    v_sub_f32 v142, v142, v169
    v_sub_f32 v143, v143, v169
    v_sub_f32 v144, v144, v169
    v_sub_f32 v145, v145, v169
    v_sub_f32 v146, v146, v169
    v_sub_f32 v147, v147, v169
    v_sub_f32 v170, 0, v169
    v_min_f32 v170, 0, v170
    v_exp_f32 v170, v170
    s_nop 0
    v_mul_f32 v68, v68, v170
    v_mul_f32 v69, v69, v170
    v_mul_f32 v70, v70, v170
    v_mul_f32 v71, v71, v170
    v_mul_f32 v72, v72, v170
    v_mul_f32 v73, v73, v170
    v_mul_f32 v74, v74, v170
    v_mul_f32 v75, v75, v170
    v_mul_f32 v76, v76, v170
    v_mul_f32 v77, v77, v170
    v_mul_f32 v78, v78, v170
    v_mul_f32 v79, v79, v170
    v_mul_f32 v80, v80, v170
    v_mul_f32 v81, v81, v170
    v_mul_f32 v82, v82, v170
    v_mul_f32 v83, v83, v170
    v_mov_b32 v168, v167
    v_mov_b32 v169, v167
    s_nop 1
    v_permlane32_swap_b32 v168, v169
    v_max_f32 v168, v168, v169
    v_max_f32 v168, s41, v168
    v_add_f32 v168, v165, v168
    v_and_b32 v168, 0xffff0000, v168
    v_sub_f32 v169, v168, v165
    v_mov_b32 v165, v168
    v_xor_b32 v170, 0x80000000, v168
    v_lshrrev_b32 v17, 16, v170
    v_sub_f32 v148, v148, v169
    v_sub_f32 v149, v149, v169
    v_sub_f32 v150, v150, v169
    v_sub_f32 v151, v151, v169
    v_sub_f32 v152, v152, v169
    v_sub_f32 v153, v153, v169
    v_sub_f32 v154, v154, v169
    v_sub_f32 v155, v155, v169
    v_sub_f32 v156, v156, v169
    v_sub_f32 v157, v157, v169
    v_sub_f32 v158, v158, v169
    v_sub_f32 v159, v159, v169
    v_sub_f32 v160, v160, v169
    v_sub_f32 v161, v161, v169
    v_sub_f32 v162, v162, v169
    v_sub_f32 v163, v163, v169
    v_sub_f32 v170, 0, v169
    v_min_f32 v170, 0, v170
    v_exp_f32 v170, v170
    s_nop 0
    v_mul_f32 v84, v84, v170
    v_mul_f32 v85, v85, v170
    v_mul_f32 v86, v86, v170
    v_mul_f32 v87, v87, v170
    v_mul_f32 v88, v88, v170
    v_mul_f32 v89, v89, v170
    v_mul_f32 v90, v90, v170
    v_mul_f32 v91, v91, v170
    v_mul_f32 v92, v92, v170
    v_mul_f32 v93, v93, v170
    v_mul_f32 v94, v94, v170
    v_mul_f32 v95, v95, v170
    v_mul_f32 v96, v96, v170
    v_mul_f32 v97, v97, v170
    v_mul_f32 v98, v98, v170
    v_mul_f32 v99, v99, v170
    s_mov_b32 s40, 0x41000000
    s_mov_b32 s41, 0
    s_branch att_back_22
k2_gemm_5:
    s_load_dwordx4 s[4:7], s[0:1], 48
    s_load_dwordx2 s[12:13], s[0:1], 0x60
    v_lshrrev_b32 v1, 6, v0
    s_nop 0
    v_readfirstlane_b32 s28, v1
    s_sub_u32 s3, s2, 0x100
    s_lshr_b32 s29, s3, 5
    s_lshl_b32 s29, s29, 1
    s_bfe_u32 s30, s3, 0x10002
    s_add_u32 s29, s29, s30
    s_and_b32 s30, s3, 3
    s_lshl_b32 s30, s30, 2
    s_bfe_u32 s31, s3, 0x20003
    s_add_u32 s30, s30, s31
    s_waitcnt lgkmcnt(0)
    s_mov_b32 s16, s12
    s_and_b32 s17, s13, 0xffff
    s_mov_b32 s18, 0x10000000
    s_mov_b32 s19, 0x20000
    s_mov_b32 s20, s4
    s_and_b32 s21, s5, 0xffff
    s_mov_b32 s22, 0x510000
    s_mov_b32 s23, 0x20000
    s_mov_b32 s24, s6
    s_and_b32 s25, s7, 0xffff
    s_mov_b32 s26, 0x2400
    s_mov_b32 s27, 0x20000
    s_mul_i32 s32, s29, 0x24000
    s_add_u32 s32, s32, 0x240000
    s_mul_i32 s33, s30, 0x240
    s_mov_b32 s34, 18
    s_mov_b32 s36, s33
    v_mov_b32 v241, v0
    v_and_b32 v233, 63, v241
    s_lshl_b32 s50, s28, 1
    s_add_u32 s50, s50, 0
    s_mul_i32 s51, s50, 0x4800
    v_lshlrev_b32 v234, 4, v233
    v_add_u32 v220, s51, v234
    s_lshl_b32 s40, s50, 10
    s_lshl_b32 s50, s28, 1
    s_add_u32 s50, s50, 1
    s_mul_i32 s51, s50, 0x4800
    v_lshlrev_b32 v234, 4, v233
    v_add_u32 v221, s51, v234
    s_lshl_b32 s41, s50, 10
    s_lshl_b32 s50, s28, 6
    s_add_u32 s50, s50, 0
    v_add_u32 v234, s50, v233
    v_mul_u32_u24 v235, 0x71d, v234
    v_lshrrev_b32 v235, 16, v235
    v_mul_u32_u24 v236, 36, v235
    v_sub_u32 v236, v234, v236
    v_lshrrev_b32 v237, 2, v235
    v_and_b32 v237, 2, v237
    v_xor_b32 v236, v236, v237
    s_mov_b32 s51, 0x2400
    v_mul_lo_u32 v235, v235, s51
    v_lshl_add_u32 v222, v236, 4, v235
    s_lshl_b32 s42, s50, 4
    s_add_u32 s42, s42, 0x2000
    s_lshl_b32 s50, s28, 6
    s_add_u32 s50, s50, 0x100
    v_add_u32 v234, s50, v233
    v_mul_u32_u24 v235, 0x71d, v234
    v_lshrrev_b32 v235, 16, v235
    v_mul_u32_u24 v236, 36, v235
    v_sub_u32 v236, v234, v236
    v_lshrrev_b32 v237, 2, v235
    v_and_b32 v237, 2, v237
    v_xor_b32 v236, v236, v237
    s_mov_b32 s51, 0x2400
    v_mul_lo_u32 v235, v235, s51
    v_lshl_add_u32 v223, v236, 4, v235
    s_lshl_b32 s43, s50, 4
    s_add_u32 s43, s43, 0x2000
    s_lshl_b32 s50, s28, 6
    s_add_u32 s50, s50, 0x200
    v_add_u32 v234, s50, v233
    v_mul_u32_u24 v235, 0x71d, v234
    v_lshrrev_b32 v235, 16, v235
    v_mul_u32_u24 v236, 36, v235
    v_sub_u32 v236, v234, v236
    v_lshrrev_b32 v237, 2, v235
    v_and_b32 v237, 2, v237
    v_xor_b32 v236, v236, v237
    s_mov_b32 s51, 0x2400
    v_mul_lo_u32 v235, v235, s51
    v_lshl_add_u32 v224, v236, 4, v235
    s_lshl_b32 s44, s50, 4
    s_add_u32 s44, s44, 0x2000
    s_lshl_b32 s50, s28, 6
    s_add_u32 s50, s50, 0x300
    v_add_u32 v234, s50, v233
    v_mul_u32_u24 v235, 0x71d, v234
    v_lshrrev_b32 v235, 16, v235
    v_mul_u32_u24 v236, 36, v235
    v_sub_u32 v236, v234, v236
    v_lshrrev_b32 v237, 2, v235
    v_and_b32 v237, 2, v237
    v_xor_b32 v236, v236, v237
    s_mov_b32 s51, 0x2400
    v_mul_lo_u32 v235, v235, s51
    v_lshl_add_u32 v225, v236, 4, v235
    s_lshl_b32 s45, s50, 4
    s_add_u32 s45, s45, 0x2000
    s_lshl_b32 s50, s28, 5
    s_add_u32 s50, s50, 0x400
    v_add_u32 v234, s50, v233
    v_mul_u32_u24 v235, 0x71d, v234
    v_lshrrev_b32 v235, 16, v235
    v_mul_u32_u24 v236, 36, v235
    v_sub_u32 v236, v234, v236
    v_lshrrev_b32 v237, 2, v235
    v_and_b32 v237, 2, v237
    v_xor_b32 v236, v236, v237
    s_mov_b32 s51, 0x2400
    v_mul_lo_u32 v235, v235, s51
    v_lshl_add_u32 v226, v236, 4, v235
    s_lshl_b32 s46, s50, 4
    s_add_u32 s46, s46, 0x2000
    v_and_b32 v234, 15, v233
    v_lshrrev_b32 v235, 4, v233
    s_lshr_b32 s50, s28, 1
    s_lshl_b32 s50, s50, 12
    v_lshlrev_b32 v236, 4, v233
    v_add_u32 v227, s50, v236
    v_lshrrev_b32 v236, 2, v234
    v_lshl_add_u32 v236, v235, 3, v236
    v_mul_u32_u24 v236, 0x240, v236
    v_and_b32 v237, 3, v233
    v_lshl_add_u32 v236, v237, 3, v236
    s_and_b32 s50, s28, 1
    s_mul_i32 s51, s50, 0x120
    s_add_u32 s51, s51, 0x2000
    v_add_u32 v236, s51, v236
    v_and_b32 v237, 1, v235
    v_lshlrev_b32 v237, 5, v237
    v_add_u32 v238, v236, v237
    v_sub_u32 v239, v236, v237
    s_cmp_eq_u32 s50, 0
    s_cselect_b64 s[52:53], -1, 0
    v_cndmask_b32 v228, v239, v238, s[52:53]
    v_cndmask_b32 v229, v238, v239, s[52:53]
    v_bfe_u32 v242, v241, 4, 2
    v_lshlrev_b32 v242, 3, v242
    s_and_b32 s35, s28, 1
    s_mul_i32 s35, s35, 0x120
    s_add_u32 s35, s35, s36
    buffer_load_dwordx2 v[144:145], v242, s[24:27], s35 offen offset:0
    buffer_load_dwordx2 v[146:147], v242, s[24:27], s35 offen offset:32
    buffer_load_dwordx2 v[148:149], v242, s[24:27], s35 offen offset:64
    buffer_load_dwordx2 v[150:151], v242, s[24:27], s35 offen offset:96
    buffer_load_dwordx2 v[152:153], v242, s[24:27], s35 offen offset:128
    buffer_load_dwordx2 v[154:155], v242, s[24:27], s35 offen offset:160
    buffer_load_dwordx2 v[156:157], v242, s[24:27], s35 offen offset:192
    buffer_load_dwordx2 v[158:159], v242, s[24:27], s35 offen offset:224
    buffer_load_dwordx2 v[160:161], v242, s[24:27], s35 offen offset:256
    s_mov_b32 s50, 0
    s_add_u32 m0, s50, s40
    s_nop 0
    buffer_load_dwordx4 v220, s[16:19], s32 offen lds
    s_add_u32 m0, s50, s41
    s_nop 0
    buffer_load_dwordx4 v221, s[16:19], s32 offen lds
    s_add_u32 m0, s50, s42
    s_nop 0
    buffer_load_dwordx4 v222, s[20:23], s33 offen lds
    s_add_u32 m0, s50, s43
    s_nop 0
    buffer_load_dwordx4 v223, s[20:23], s33 offen lds
    s_add_u32 m0, s50, s44
    s_nop 0
    buffer_load_dwordx4 v224, s[20:23], s33 offen lds
    s_add_u32 m0, s50, s45
    s_nop 0
    buffer_load_dwordx4 v225, s[20:23], s33 offen lds
    s_add_u32 m0, s50, s46
    s_mov_b32 exec_hi, 0
    buffer_load_dwordx4 v226, s[20:23], s33 offen lds
    s_mov_b64 exec, -1
    s_add_u32 s32, s32, 0x400
    s_add_u32 s33, s33, 0x48000
    s_mov_b32 s50, 0x6800
    s_add_u32 m0, s50, s40
    s_nop 0
    buffer_load_dwordx4 v220, s[16:19], s32 offen lds
    s_add_u32 m0, s50, s41
    s_nop 0
    buffer_load_dwordx4 v221, s[16:19], s32 offen lds
    s_add_u32 m0, s50, s42
    s_nop 0
    buffer_load_dwordx4 v222, s[20:23], s33 offen lds
    s_add_u32 m0, s50, s43
    s_nop 0
    buffer_load_dwordx4 v223, s[20:23], s33 offen lds
    s_add_u32 m0, s50, s44
    s_nop 0
    buffer_load_dwordx4 v224, s[20:23], s33 offen lds
    s_add_u32 m0, s50, s45
    s_nop 0
    buffer_load_dwordx4 v225, s[20:23], s33 offen lds
    s_add_u32 m0, s50, s46
    s_mov_b32 exec_hi, 0
    buffer_load_dwordx4 v226, s[20:23], s33 offen lds
    s_mov_b64 exec, -1
    s_add_u32 s32, s32, 0x400
    s_add_u32 s33, s33, 0x48000
    s_mov_b32 s50, 0xd000
    s_add_u32 m0, s50, s40
    s_nop 0
    buffer_load_dwordx4 v220, s[16:19], s32 offen lds
    s_add_u32 m0, s50, s41
    s_nop 0
    buffer_load_dwordx4 v221, s[16:19], s32 offen lds
    s_add_u32 m0, s50, s42
    s_nop 0
    buffer_load_dwordx4 v222, s[20:23], s33 offen lds
    s_add_u32 m0, s50, s43
    s_nop 0
    buffer_load_dwordx4 v223, s[20:23], s33 offen lds
    s_add_u32 m0, s50, s44
    s_nop 0
    buffer_load_dwordx4 v224, s[20:23], s33 offen lds
    s_add_u32 m0, s50, s45
    s_nop 0
    buffer_load_dwordx4 v225, s[20:23], s33 offen lds
    s_add_u32 m0, s50, s46
    s_mov_b32 exec_hi, 0
    buffer_load_dwordx4 v226, s[20:23], s33 offen lds
    s_mov_b64 exec, -1
    s_add_u32 s32, s32, 0x400
    s_add_u32 s33, s33, 0x48000
    s_waitcnt vmcnt(21)
    v_lshlrev_b32 v0, 16, v144
    v_and_b32 v1, 0xffff0000, v144
    v_lshlrev_b32 v2, 16, v145
    v_and_b32 v3, 0xffff0000, v145
    v_mov_b32 v4, v0
    v_mov_b32 v5, v1
    v_mov_b32 v6, v2
    v_mov_b32 v7, v3
    v_mov_b32 v8, v0
    v_mov_b32 v9, v1
    v_mov_b32 v10, v2
    v_mov_b32 v11, v3
    v_mov_b32 v12, v0
    v_mov_b32 v13, v1
    v_mov_b32 v14, v2
    v_mov_b32 v15, v3
    v_lshlrev_b32 v16, 16, v146
    v_and_b32 v17, 0xffff0000, v146
    v_lshlrev_b32 v18, 16, v147
    v_and_b32 v19, 0xffff0000, v147
    v_mov_b32 v20, v16
    v_mov_b32 v21, v17
    v_mov_b32 v22, v18
    v_mov_b32 v23, v19
    v_mov_b32 v24, v16
    v_mov_b32 v25, v17
    v_mov_b32 v26, v18
    v_mov_b32 v27, v19
    v_mov_b32 v28, v16
    v_mov_b32 v29, v17
    v_mov_b32 v30, v18
    v_mov_b32 v31, v19
    v_lshlrev_b32 v32, 16, v148
    v_and_b32 v33, 0xffff0000, v148
    v_lshlrev_b32 v34, 16, v149
    v_and_b32 v35, 0xffff0000, v149
    v_mov_b32 v36, v32
    v_mov_b32 v37, v33
    v_mov_b32 v38, v34
    v_mov_b32 v39, v35
    v_mov_b32 v40, v32
    v_mov_b32 v41, v33
    v_mov_b32 v42, v34
    v_mov_b32 v43, v35
    v_mov_b32 v44, v32
    v_mov_b32 v45, v33
    v_mov_b32 v46, v34
    v_mov_b32 v47, v35
    v_lshlrev_b32 v48, 16, v150
    v_and_b32 v49, 0xffff0000, v150
    v_lshlrev_b32 v50, 16, v151
    v_and_b32 v51, 0xffff0000, v151
    v_mov_b32 v52, v48
    v_mov_b32 v53, v49
    v_mov_b32 v54, v50
    v_mov_b32 v55, v51
    v_mov_b32 v56, v48
    v_mov_b32 v57, v49
    v_mov_b32 v58, v50
    v_mov_b32 v59, v51
    v_mov_b32 v60, v48
    v_mov_b32 v61, v49
    v_mov_b32 v62, v50
    v_mov_b32 v63, v51
    v_lshlrev_b32 v64, 16, v152
    v_and_b32 v65, 0xffff0000, v152
    v_lshlrev_b32 v66, 16, v153
    v_and_b32 v67, 0xffff0000, v153
    v_mov_b32 v68, v64
    v_mov_b32 v69, v65
    v_mov_b32 v70, v66
    v_mov_b32 v71, v67
    v_mov_b32 v72, v64
    v_mov_b32 v73, v65
    v_mov_b32 v74, v66
    v_mov_b32 v75, v67
    v_mov_b32 v76, v64
    v_mov_b32 v77, v65
    v_mov_b32 v78, v66
    v_mov_b32 v79, v67
    v_lshlrev_b32 v80, 16, v154
    v_and_b32 v81, 0xffff0000, v154
    v_lshlrev_b32 v82, 16, v155
    v_and_b32 v83, 0xffff0000, v155
    v_mov_b32 v84, v80
    v_mov_b32 v85, v81
    v_mov_b32 v86, v82
    v_mov_b32 v87, v83
    v_mov_b32 v88, v80
    v_mov_b32 v89, v81
    v_mov_b32 v90, v82
    v_mov_b32 v91, v83
    v_mov_b32 v92, v80
    v_mov_b32 v93, v81
    v_mov_b32 v94, v82
    v_mov_b32 v95, v83
    v_lshlrev_b32 v96, 16, v156
    v_and_b32 v97, 0xffff0000, v156
    v_lshlrev_b32 v98, 16, v157
    v_and_b32 v99, 0xffff0000, v157
    v_mov_b32 v100, v96
    v_mov_b32 v101, v97
    v_mov_b32 v102, v98
    v_mov_b32 v103, v99
    v_mov_b32 v104, v96
    v_mov_b32 v105, v97
    v_mov_b32 v106, v98
    v_mov_b32 v107, v99
    v_mov_b32 v108, v96
    v_mov_b32 v109, v97
    v_mov_b32 v110, v98
    v_mov_b32 v111, v99
    v_lshlrev_b32 v112, 16, v158
    v_and_b32 v113, 0xffff0000, v158
    v_lshlrev_b32 v114, 16, v159
    v_and_b32 v115, 0xffff0000, v159
    v_mov_b32 v116, v112
    v_mov_b32 v117, v113
    v_mov_b32 v118, v114
    v_mov_b32 v119, v115
    v_mov_b32 v120, v112
    v_mov_b32 v121, v113
    v_mov_b32 v122, v114
    v_mov_b32 v123, v115
    v_mov_b32 v124, v112
    v_mov_b32 v125, v113
    v_mov_b32 v126, v114
    v_mov_b32 v127, v115
    v_lshlrev_b32 v128, 16, v160
    v_and_b32 v129, 0xffff0000, v160
    v_lshlrev_b32 v130, 16, v161
    v_and_b32 v131, 0xffff0000, v161
    v_mov_b32 v132, v128
    v_mov_b32 v133, v129
    v_mov_b32 v134, v130
    v_mov_b32 v135, v131
    v_mov_b32 v136, v128
    v_mov_b32 v137, v129
    v_mov_b32 v138, v130
    v_mov_b32 v139, v131
    v_mov_b32 v140, v128
    v_mov_b32 v141, v129
    v_mov_b32 v142, v130
    v_mov_b32 v143, v131
    s_waitcnt vmcnt(14)
    s_barrier
    s_mov_b32 s47, 0
    v_add_u32 v230, s47, v227
    v_add_u32 v231, s47, v228
    v_add_u32 v232, s47, v229
    ds_read_b128 v[188:191], v230 offset:0
    ds_read_b128 v[192:195], v230 offset:1024
    ds_read_b128 v[196:199], v230 offset:2048
    ds_read_b128 v[200:203], v230 offset:3072
    ds_read_b64_tr_b16 v[144:145], v231 offset:0
    ds_read_b64_tr_b16 v[146:147], v231 offset:2304
    ds_read_b64_tr_b16 v[148:149], v232 offset:32
    ds_read_b64_tr_b16 v[150:151], v232 offset:2336
    ds_read_b64_tr_b16 v[152:153], v231 offset:64
    ds_read_b64_tr_b16 v[154:155], v231 offset:2368
    ds_read_b64_tr_b16 v[156:157], v232 offset:96
    ds_read_b64_tr_b16 v[158:159], v232 offset:2400
    ds_read_b64_tr_b16 v[160:161], v231 offset:128
    ds_read_b64_tr_b16 v[162:163], v231 offset:2432
    ds_read_b64_tr_b16 v[164:165], v232 offset:160
    ds_read_b64_tr_b16 v[166:167], v232 offset:2464
    ds_read_b64_tr_b16 v[168:169], v231 offset:192
    ds_read_b64_tr_b16 v[170:171], v231 offset:2496
    ds_read_b64_tr_b16 v[172:173], v232 offset:224
    ds_read_b64_tr_b16 v[174:175], v232 offset:2528
    ds_read_b64_tr_b16 v[176:177], v231 offset:256
    ds_read_b64_tr_b16 v[178:179], v231 offset:2560
    s_mov_b32 s47, 0x6800
    s_mov_b32 s48, 0
    s_mov_b32 s49, 0
gemm_loop_23:
    s_add_u32 s50, s49, 2
    s_cmp_lt_u32 s50, s34
    s_cbranch_scc1 gw0_25
    s_waitcnt vmcnt(0) lgkmcnt(0)
    s_branch gw1_26
gw0_25:
    s_waitcnt vmcnt(7) lgkmcnt(0)
gw1_26:
    s_barrier
    v_add_u32 v230, s47, v227
    v_add_u32 v231, s47, v228
    v_add_u32 v232, s47, v229
    s_add_u32 s50, s49, 3
    s_cmp_lt_u32 s50, s34
    s_cbranch_scc0 gnd_27
    s_add_u32 m0, s48, s40
    s_nop 0
    buffer_load_dwordx4 v220, s[16:19], s32 offen lds
    s_add_u32 m0, s48, s41
    s_nop 0
    buffer_load_dwordx4 v221, s[16:19], s32 offen lds
    s_add_u32 m0, s48, s42
    s_nop 0
    buffer_load_dwordx4 v222, s[20:23], s33 offen lds
    s_add_u32 m0, s48, s43
    s_nop 0
    buffer_load_dwordx4 v223, s[20:23], s33 offen lds
    s_add_u32 m0, s48, s44
    s_nop 0
    buffer_load_dwordx4 v224, s[20:23], s33 offen lds
    s_add_u32 m0, s48, s45
    s_nop 0
    buffer_load_dwordx4 v225, s[20:23], s33 offen lds
    s_add_u32 m0, s48, s46
    s_mov_b32 exec_hi, 0
    buffer_load_dwordx4 v226, s[20:23], s33 offen lds
    s_mov_b64 exec, -1
    s_add_u32 s32, s32, 0x400
    s_add_u32 s33, s33, 0x48000
gnd_27:
    ds_read_b64_tr_b16 v[180:181], v232 offset:224
    ds_read_b64_tr_b16 v[182:183], v232 offset:2528
    ds_read_b64_tr_b16 v[184:185], v231 offset:256
    ds_read_b64_tr_b16 v[186:187], v231 offset:2560
    v_mfma_f32_16x16x32_bf16 v[0:3], v[144:147], v[188:191], v[0:3]
    v_mfma_f32_16x16x32_bf16 v[4:7], v[144:147], v[192:195], v[4:7]
    v_mfma_f32_16x16x32_bf16 v[8:11], v[144:147], v[196:199], v[8:11]
    v_mfma_f32_16x16x32_bf16 v[12:15], v[144:147], v[200:203], v[12:15]
    ds_read_b64_tr_b16 v[144:145], v231 offset:0
    ds_read_b64_tr_b16 v[146:147], v231 offset:2304
    ds_read_b128 v[204:207], v230 offset:0
    v_mfma_f32_16x16x32_bf16 v[16:19], v[148:151], v[188:191], v[16:19]
    v_mfma_f32_16x16x32_bf16 v[20:23], v[148:151], v[192:195], v[20:23]
    v_mfma_f32_16x16x32_bf16 v[24:27], v[148:151], v[196:199], v[24:27]
    v_mfma_f32_16x16x32_bf16 v[28:31], v[148:151], v[200:203], v[28:31]
    ds_read_b64_tr_b16 v[148:149], v232 offset:32
    ds_read_b64_tr_b16 v[150:151], v232 offset:2336
    ds_read_b128 v[208:211], v230 offset:1024
    v_mfma_f32_16x16x32_bf16 v[32:35], v[152:155], v[188:191], v[32:35]
    v_mfma_f32_16x16x32_bf16 v[36:39], v[152:155], v[192:195], v[36:39]
    v_mfma_f32_16x16x32_bf16 v[40:43], v[152:155], v[196:199], v[40:43]
    v_mfma_f32_16x16x32_bf16 v[44:47], v[152:155], v[200:203], v[44:47]
    ds_read_b64_tr_b16 v[152:153], v231 offset:64
    ds_read_b64_tr_b16 v[154:155], v231 offset:2368
    ds_read_b128 v[212:215], v230 offset:2048
    v_mfma_f32_16x16x32_bf16 v[48:51], v[156:159], v[188:191], v[48:51]
    v_mfma_f32_16x16x32_bf16 v[52:55], v[156:159], v[192:195], v[52:55]
    v_mfma_f32_16x16x32_bf16 v[56:59], v[156:159], v[196:199], v[56:59]
    v_mfma_f32_16x16x32_bf16 v[60:63], v[156:159], v[200:203], v[60:63]
    ds_read_b64_tr_b16 v[156:157], v232 offset:96
    ds_read_b64_tr_b16 v[158:159], v232 offset:2400
    ds_read_b128 v[216:219], v230 offset:3072
    v_mfma_f32_16x16x32_bf16 v[64:67], v[160:163], v[188:191], v[64:67]
    v_mfma_f32_16x16x32_bf16 v[68:71], v[160:163], v[192:195], v[68:71]
    v_mfma_f32_16x16x32_bf16 v[72:75], v[160:163], v[196:199], v[72:75]
    v_mfma_f32_16x16x32_bf16 v[76:79], v[160:163], v[200:203], v[76:79]
    ds_read_b64_tr_b16 v[160:161], v231 offset:128
    ds_read_b64_tr_b16 v[162:163], v231 offset:2432
    v_mfma_f32_16x16x32_bf16 v[80:83], v[164:167], v[188:191], v[80:83]
    v_mfma_f32_16x16x32_bf16 v[84:87], v[164:167], v[192:195], v[84:87]
    v_mfma_f32_16x16x32_bf16 v[88:91], v[164:167], v[196:199], v[88:91]
    v_mfma_f32_16x16x32_bf16 v[92:95], v[164:167], v[200:203], v[92:95]
    ds_read_b64_tr_b16 v[164:165], v232 offset:160
    ds_read_b64_tr_b16 v[166:167], v232 offset:2464
    v_mfma_f32_16x16x32_bf16 v[96:99], v[168:171], v[188:191], v[96:99]
    v_mfma_f32_16x16x32_bf16 v[100:103], v[168:171], v[192:195], v[100:103]
    v_mfma_f32_16x16x32_bf16 v[104:107], v[168:171], v[196:199], v[104:107]
    v_mfma_f32_16x16x32_bf16 v[108:111], v[168:171], v[200:203], v[108:111]
    ds_read_b64_tr_b16 v[168:169], v231 offset:192
    ds_read_b64_tr_b16 v[170:171], v231 offset:2496
    v_mfma_f32_16x16x32_bf16 v[112:115], v[172:175], v[188:191], v[112:115]
    v_mfma_f32_16x16x32_bf16 v[116:119], v[172:175], v[192:195], v[116:119]
    v_mfma_f32_16x16x32_bf16 v[120:123], v[172:175], v[196:199], v[120:123]
    v_mfma_f32_16x16x32_bf16 v[124:127], v[172:175], v[200:203], v[124:127]
    v_mfma_f32_16x16x32_bf16 v[128:131], v[176:179], v[188:191], v[128:131]
    v_mfma_f32_16x16x32_bf16 v[132:135], v[176:179], v[192:195], v[132:135]
    v_mfma_f32_16x16x32_bf16 v[136:139], v[176:179], v[196:199], v[136:139]
    v_mfma_f32_16x16x32_bf16 v[140:143], v[176:179], v[200:203], v[140:143]
    s_mov_b32 s48, s47
    s_add_u32 s47, s47, 0x6800
    s_cmp_eq_u32 s47, 0x13800
    s_cselect_b32 s47, 0, s47
    s_add_u32 s49, s49, 1
    s_cmp_lt_u32 s49, s34
    s_cbranch_scc0 gemm_done_24
    s_add_u32 s50, s49, 2
    s_cmp_lt_u32 s50, s34
    s_cbranch_scc1 gw0_28
    s_waitcnt vmcnt(0) lgkmcnt(0)
    s_branch gw1_29
gw0_28:
    s_waitcnt vmcnt(7) lgkmcnt(0)
gw1_29:
    s_barrier
    v_add_u32 v230, s47, v227
    v_add_u32 v231, s47, v228
    v_add_u32 v232, s47, v229
    s_add_u32 s50, s49, 3
    s_cmp_lt_u32 s50, s34
    s_cbranch_scc0 gnd_30
    s_add_u32 m0, s48, s40
    s_nop 0
    buffer_load_dwordx4 v220, s[16:19], s32 offen lds
    s_add_u32 m0, s48, s41
    s_nop 0
    buffer_load_dwordx4 v221, s[16:19], s32 offen lds
    s_add_u32 m0, s48, s42
    s_nop 0
    buffer_load_dwordx4 v222, s[20:23], s33 offen lds
    s_add_u32 m0, s48, s43
    s_nop 0
    buffer_load_dwordx4 v223, s[20:23], s33 offen lds
    s_add_u32 m0, s48, s44
    s_nop 0
    buffer_load_dwordx4 v224, s[20:23], s33 offen lds
    s_add_u32 m0, s48, s45
    s_nop 0
    buffer_load_dwordx4 v225, s[20:23], s33 offen lds
    s_add_u32 m0, s48, s46
    s_mov_b32 exec_hi, 0
    buffer_load_dwordx4 v226, s[20:23], s33 offen lds
    s_mov_b64 exec, -1
    s_add_u32 s32, s32, 0x400
    s_add_u32 s33, s33, 0x48000
gnd_30:
    ds_read_b64_tr_b16 v[172:173], v232 offset:224
    ds_read_b64_tr_b16 v[174:175], v232 offset:2528
    ds_read_b64_tr_b16 v[176:177], v231 offset:256
    ds_read_b64_tr_b16 v[178:179], v231 offset:2560
    v_mfma_f32_16x16x32_bf16 v[0:3], v[144:147], v[204:207], v[0:3]
    v_mfma_f32_16x16x32_bf16 v[4:7], v[144:147], v[208:211], v[4:7]
    v_mfma_f32_16x16x32_bf16 v[8:11], v[144:147], v[212:215], v[8:11]
    v_mfma_f32_16x16x32_bf16 v[12:15], v[144:147], v[216:219], v[12:15]
    ds_read_b64_tr_b16 v[144:145], v231 offset:0
    ds_read_b64_tr_b16 v[146:147], v231 offset:2304
    ds_read_b128 v[188:191], v230 offset:0
    v_mfma_f32_16x16x32_bf16 v[16:19], v[148:151], v[204:207], v[16:19]
    v_mfma_f32_16x16x32_bf16 v[20:23], v[148:151], v[208:211], v[20:23]
    v_mfma_f32_16x16x32_bf16 v[24:27], v[148:151], v[212:215], v[24:27]
    v_mfma_f32_16x16x32_bf16 v[28:31], v[148:151], v[216:219], v[28:31]
    ds_read_b64_tr_b16 v[148:149], v232 offset:32
    ds_read_b64_tr_b16 v[150:151], v232 offset:2336
    ds_read_b128 v[192:195], v230 offset:1024
    v_mfma_f32_16x16x32_bf16 v[32:35], v[152:155], v[204:207], v[32:35]
    v_mfma_f32_16x16x32_bf16 v[36:39], v[152:155], v[208:211], v[36:39]
    v_mfma_f32_16x16x32_bf16 v[40:43], v[152:155], v[212:215], v[40:43]
    v_mfma_f32_16x16x32_bf16 v[44:47], v[152:155], v[216:219], v[44:47]
    ds_read_b64_tr_b16 v[152:153], v231 offset:64
    ds_read_b64_tr_b16 v[154:155], v231 offset:2368
    ds_read_b128 v[196:199], v230 offset:2048
    v_mfma_f32_16x16x32_bf16 v[48:51], v[156:159], v[204:207], v[48:51]
    v_mfma_f32_16x16x32_bf16 v[52:55], v[156:159], v[208:211], v[52:55]
    v_mfma_f32_16x16x32_bf16 v[56:59], v[156:159], v[212:215], v[56:59]
    v_mfma_f32_16x16x32_bf16 v[60:63], v[156:159], v[216:219], v[60:63]
    ds_read_b64_tr_b16 v[156:157], v232 offset:96
    ds_read_b64_tr_b16 v[158:159], v232 offset:2400
    ds_read_b128 v[200:203], v230 offset:3072
    v_mfma_f32_16x16x32_bf16 v[64:67], v[160:163], v[204:207], v[64:67]
    v_mfma_f32_16x16x32_bf16 v[68:71], v[160:163], v[208:211], v[68:71]
    v_mfma_f32_16x16x32_bf16 v[72:75], v[160:163], v[212:215], v[72:75]
    v_mfma_f32_16x16x32_bf16 v[76:79], v[160:163], v[216:219], v[76:79]
    ds_read_b64_tr_b16 v[160:161], v231 offset:128
    ds_read_b64_tr_b16 v[162:163], v231 offset:2432
    v_mfma_f32_16x16x32_bf16 v[80:83], v[164:167], v[204:207], v[80:83]
    v_mfma_f32_16x16x32_bf16 v[84:87], v[164:167], v[208:211], v[84:87]
    v_mfma_f32_16x16x32_bf16 v[88:91], v[164:167], v[212:215], v[88:91]
    v_mfma_f32_16x16x32_bf16 v[92:95], v[164:167], v[216:219], v[92:95]
    ds_read_b64_tr_b16 v[164:165], v232 offset:160
    ds_read_b64_tr_b16 v[166:167], v232 offset:2464
    v_mfma_f32_16x16x32_bf16 v[96:99], v[168:171], v[204:207], v[96:99]
    v_mfma_f32_16x16x32_bf16 v[100:103], v[168:171], v[208:211], v[100:103]
    v_mfma_f32_16x16x32_bf16 v[104:107], v[168:171], v[212:215], v[104:107]
    v_mfma_f32_16x16x32_bf16 v[108:111], v[168:171], v[216:219], v[108:111]
    ds_read_b64_tr_b16 v[168:169], v231 offset:192
    ds_read_b64_tr_b16 v[170:171], v231 offset:2496
    v_mfma_f32_16x16x32_bf16 v[112:115], v[180:183], v[204:207], v[112:115]
    v_mfma_f32_16x16x32_bf16 v[116:119], v[180:183], v[208:211], v[116:119]
    v_mfma_f32_16x16x32_bf16 v[120:123], v[180:183], v[212:215], v[120:123]
    v_mfma_f32_16x16x32_bf16 v[124:127], v[180:183], v[216:219], v[124:127]
    v_mfma_f32_16x16x32_bf16 v[128:131], v[184:187], v[204:207], v[128:131]
    v_mfma_f32_16x16x32_bf16 v[132:135], v[184:187], v[208:211], v[132:135]
    v_mfma_f32_16x16x32_bf16 v[136:139], v[184:187], v[212:215], v[136:139]
    v_mfma_f32_16x16x32_bf16 v[140:143], v[184:187], v[216:219], v[140:143]
    s_mov_b32 s48, s47
    s_add_u32 s47, s47, 0x6800
    s_cmp_eq_u32 s47, 0x13800
    s_cselect_b32 s47, 0, s47
    s_add_u32 s49, s49, 1
    s_cmp_lt_u32 s49, s34
    s_cbranch_scc1 gemm_loop_23
gemm_done_24:
    s_waitcnt lgkmcnt(0)
    s_mov_b32 s60, 0xbdd2d3e8
    s_mov_b32 s61, 0xc0135761
    v_and_b32 v148, 15, v241
    v_bfe_u32 v149, v241, 4, 2
    s_and_b32 s62, s28, 1
    s_lshl_b32 s63, s62, 1
    v_and_b32 v144, 1, v149
    v_lshrrev_b32 v145, 1, v149
    v_lshl_add_u32 v144, v144, 1, v145
    v_add_u32 v144, s63, v144
    v_lshlrev_b32 v144, 8, v144
    v_lshl_add_u32 v146, v148, 4, v144
    v_add_u32 v145, s63, v145
    v_lshlrev_b32 v145, 8, v145
    v_lshl_add_u32 v147, v148, 4, v145
    v_and_b32 v144, 1, v149
    v_lshl_add_u32 v147, v144, 3, v147
    s_lshr_b32 s63, s28, 1
    s_lshl_b32 s63, s63, 2
    s_lshl_b32 s35, s29, 3
    s_add_u32 s35, s35, s63
    s_mul_i32 s35, s35, 0xa2
    s_mul_i32 s63, s30, 9
    s_add_u32 s35, s35, s63
    s_lshl_b32 s62, s62, 2
    s_add_u32 s35, s35, s62
    s_lshl_b32 s35, s35, 10
    s_add_u32 s35, s35, 0x600000
    s_add_u32 s64, s35, 0
    s_add_u32 s68, s35, 0x1000
    s_add_u32 s65, s35, 0x28800
    s_add_u32 s69, s35, 0x29800
    s_add_u32 s66, s35, 0x51000
    s_add_u32 s70, s35, 0x52000
    s_add_u32 s67, s35, 0x79800
    s_add_u32 s71, s35, 0x7a800
    v_mov_b32 v156, s60
    v_mov_b32 v158, s61
    v_mov_b32 v160, 1.0
    v_mov_b32 v157, s60
    v_mov_b32 v159, s61
    v_mov_b32 v161, 1.0
    v_pk_mul_f32 v[162:163], v[0:1], v[0:1]
    v_pk_fma_f32 v[162:163], v[162:163], v[156:157], v[158:159]
    v_pk_mul_f32 v[162:163], v[162:163], v[0:1]
    v_pk_mul_f32 v[164:165], v[2:3], v[2:3]
    v_pk_fma_f32 v[164:165], v[164:165], v[156:157], v[158:159]
    v_pk_mul_f32 v[164:165], v[164:165], v[2:3]
    v_exp_f32 v162, v162
    v_exp_f32 v163, v163
    v_exp_f32 v164, v164
    v_exp_f32 v165, v165
    v_pk_add_f32 v[162:163], v[162:163], v[160:161]
    v_pk_add_f32 v[164:165], v[164:165], v[160:161]
    v_rcp_f32 v162, v162
    v_rcp_f32 v163, v163
    v_rcp_f32 v164, v164
    v_rcp_f32 v165, v165
    v_pk_mul_f32 v[0:1], v[0:1], v[162:163]
    v_pk_mul_f32 v[2:3], v[2:3], v[164:165]
    v_cvt_pk_bf16_f32 v152, v0, v1
    v_cvt_pk_bf16_f32 v153, v2, v3
    v_pk_mul_f32 v[162:163], v[16:17], v[16:17]
    v_pk_fma_f32 v[162:163], v[162:163], v[156:157], v[158:159]
    v_pk_mul_f32 v[162:163], v[162:163], v[16:17]
    v_pk_mul_f32 v[164:165], v[18:19], v[18:19]
    v_pk_fma_f32 v[164:165], v[164:165], v[156:157], v[158:159]
    v_pk_mul_f32 v[164:165], v[164:165], v[18:19]
    v_exp_f32 v162, v162
    v_exp_f32 v163, v163
    v_exp_f32 v164, v164
    v_exp_f32 v165, v165
    v_pk_add_f32 v[162:163], v[162:163], v[160:161]
    v_pk_add_f32 v[164:165], v[164:165], v[160:161]
    v_rcp_f32 v162, v162
    v_rcp_f32 v163, v163
    v_rcp_f32 v164, v164
    v_rcp_f32 v165, v165
    v_pk_mul_f32 v[16:17], v[16:17], v[162:163]
    v_pk_mul_f32 v[18:19], v[18:19], v[164:165]
    v_cvt_pk_bf16_f32 v154, v16, v17
    v_cvt_pk_bf16_f32 v155, v18, v19
    s_nop 0
    v_permlane16_swap_b32 v152, v154
    s_nop 0
    v_permlane16_swap_b32 v153, v155
    buffer_store_dwordx4 v[152:155], v146, s[16:19], s64 offen offset:0
    v_pk_mul_f32 v[162:163], v[32:33], v[32:33]
    v_pk_fma_f32 v[162:163], v[162:163], v[156:157], v[158:159]
    v_pk_mul_f32 v[162:163], v[162:163], v[32:33]
    v_pk_mul_f32 v[164:165], v[34:35], v[34:35]
    v_pk_fma_f32 v[164:165], v[164:165], v[156:157], v[158:159]
    v_pk_mul_f32 v[164:165], v[164:165], v[34:35]
    v_exp_f32 v162, v162
    v_exp_f32 v163, v163
    v_exp_f32 v164, v164
    v_exp_f32 v165, v165
    v_pk_add_f32 v[162:163], v[162:163], v[160:161]
    v_pk_add_f32 v[164:165], v[164:165], v[160:161]
    v_rcp_f32 v162, v162
    v_rcp_f32 v163, v163
    v_rcp_f32 v164, v164
    v_rcp_f32 v165, v165
    v_pk_mul_f32 v[32:33], v[32:33], v[162:163]
    v_pk_mul_f32 v[34:35], v[34:35], v[164:165]
    v_cvt_pk_bf16_f32 v152, v32, v33
    v_cvt_pk_bf16_f32 v153, v34, v35
    v_pk_mul_f32 v[162:163], v[48:49], v[48:49]
    v_pk_fma_f32 v[162:163], v[162:163], v[156:157], v[158:159]
    v_pk_mul_f32 v[162:163], v[162:163], v[48:49]
    v_pk_mul_f32 v[164:165], v[50:51], v[50:51]
    v_pk_fma_f32 v[164:165], v[164:165], v[156:157], v[158:159]
    v_pk_mul_f32 v[164:165], v[164:165], v[50:51]
    v_exp_f32 v162, v162
    v_exp_f32 v163, v163
    v_exp_f32 v164, v164
    v_exp_f32 v165, v165
    v_pk_add_f32 v[162:163], v[162:163], v[160:161]
    v_pk_add_f32 v[164:165], v[164:165], v[160:161]
    v_rcp_f32 v162, v162
    v_rcp_f32 v163, v163
    v_rcp_f32 v164, v164
    v_rcp_f32 v165, v165
    v_pk_mul_f32 v[48:49], v[48:49], v[162:163]
    v_pk_mul_f32 v[50:51], v[50:51], v[164:165]
    v_cvt_pk_bf16_f32 v154, v48, v49
    v_cvt_pk_bf16_f32 v155, v50, v51
    s_nop 0
    v_permlane16_swap_b32 v152, v154
    s_nop 0
    v_permlane16_swap_b32 v153, v155
    buffer_store_dwordx4 v[152:155], v146, s[16:19], s64 offen offset:1024
    v_pk_mul_f32 v[162:163], v[64:65], v[64:65]
    v_pk_fma_f32 v[162:163], v[162:163], v[156:157], v[158:159]
    v_pk_mul_f32 v[162:163], v[162:163], v[64:65]
    v_pk_mul_f32 v[164:165], v[66:67], v[66:67]
    v_pk_fma_f32 v[164:165], v[164:165], v[156:157], v[158:159]
    v_pk_mul_f32 v[164:165], v[164:165], v[66:67]
    v_exp_f32 v162, v162
    v_exp_f32 v163, v163
    v_exp_f32 v164, v164
    v_exp_f32 v165, v165
    v_pk_add_f32 v[162:163], v[162:163], v[160:161]
    v_pk_add_f32 v[164:165], v[164:165], v[160:161]
    v_rcp_f32 v162, v162
    v_rcp_f32 v163, v163
    v_rcp_f32 v164, v164
    v_rcp_f32 v165, v165
    v_pk_mul_f32 v[64:65], v[64:65], v[162:163]
    v_pk_mul_f32 v[66:67], v[66:67], v[164:165]
    v_cvt_pk_bf16_f32 v152, v64, v65
    v_cvt_pk_bf16_f32 v153, v66, v67
    v_pk_mul_f32 v[162:163], v[80:81], v[80:81]
    v_pk_fma_f32 v[162:163], v[162:163], v[156:157], v[158:159]
    v_pk_mul_f32 v[162:163], v[162:163], v[80:81]
    v_pk_mul_f32 v[164:165], v[82:83], v[82:83]
    v_pk_fma_f32 v[164:165], v[164:165], v[156:157], v[158:159]
    v_pk_mul_f32 v[164:165], v[164:165], v[82:83]
    v_exp_f32 v162, v162
    v_exp_f32 v163, v163
    v_exp_f32 v164, v164
    v_exp_f32 v165, v165
    v_pk_add_f32 v[162:163], v[162:163], v[160:161]
    v_pk_add_f32 v[164:165], v[164:165], v[160:161]
    v_rcp_f32 v162, v162
    v_rcp_f32 v163, v163
    v_rcp_f32 v164, v164
    v_rcp_f32 v165, v165
    v_pk_mul_f32 v[80:81], v[80:81], v[162:163]
    v_pk_mul_f32 v[82:83], v[82:83], v[164:165]
    v_cvt_pk_bf16_f32 v154, v80, v81
    v_cvt_pk_bf16_f32 v155, v82, v83
    s_nop 0
    v_permlane16_swap_b32 v152, v154
    s_nop 0
    v_permlane16_swap_b32 v153, v155
    buffer_store_dwordx4 v[152:155], v146, s[16:19], s64 offen offset:2048
    v_pk_mul_f32 v[162:163], v[96:97], v[96:97]
    v_pk_fma_f32 v[162:163], v[162:163], v[156:157], v[158:159]
    v_pk_mul_f32 v[162:163], v[162:163], v[96:97]
    v_pk_mul_f32 v[164:165], v[98:99], v[98:99]
    v_pk_fma_f32 v[164:165], v[164:165], v[156:157], v[158:159]
    v_pk_mul_f32 v[164:165], v[164:165], v[98:99]
    v_exp_f32 v162, v162
    v_exp_f32 v163, v163
    v_exp_f32 v164, v164
    v_exp_f32 v165, v165
    v_pk_add_f32 v[162:163], v[162:163], v[160:161]
    v_pk_add_f32 v[164:165], v[164:165], v[160:161]
    v_rcp_f32 v162, v162
    v_rcp_f32 v163, v163
    v_rcp_f32 v164, v164
    v_rcp_f32 v165, v165
    v_pk_mul_f32 v[96:97], v[96:97], v[162:163]
    v_pk_mul_f32 v[98:99], v[98:99], v[164:165]
    v_cvt_pk_bf16_f32 v152, v96, v97
    v_cvt_pk_bf16_f32 v153, v98, v99
    v_pk_mul_f32 v[162:163], v[112:113], v[112:113]
    v_pk_fma_f32 v[162:163], v[162:163], v[156:157], v[158:159]
    v_pk_mul_f32 v[162:163], v[162:163], v[112:113]
    v_pk_mul_f32 v[164:165], v[114:115], v[114:115]
    v_pk_fma_f32 v[164:165], v[164:165], v[156:157], v[158:159]
    v_pk_mul_f32 v[164:165], v[164:165], v[114:115]
    v_exp_f32 v162, v162
    v_exp_f32 v163, v163
    v_exp_f32 v164, v164
    v_exp_f32 v165, v165
    v_pk_add_f32 v[162:163], v[162:163], v[160:161]
    v_pk_add_f32 v[164:165], v[164:165], v[160:161]
    v_rcp_f32 v162, v162
    v_rcp_f32 v163, v163
    v_rcp_f32 v164, v164
    v_rcp_f32 v165, v165
    v_pk_mul_f32 v[112:113], v[112:113], v[162:163]
    v_pk_mul_f32 v[114:115], v[114:115], v[164:165]
    v_cvt_pk_bf16_f32 v154, v112, v113
    v_cvt_pk_bf16_f32 v155, v114, v115
    s_nop 0
    v_permlane16_swap_b32 v152, v154
    s_nop 0
    v_permlane16_swap_b32 v153, v155
    buffer_store_dwordx4 v[152:155], v146, s[16:19], s64 offen offset:3072
    v_pk_mul_f32 v[162:163], v[128:129], v[128:129]
    v_pk_fma_f32 v[162:163], v[162:163], v[156:157], v[158:159]
    v_pk_mul_f32 v[162:163], v[162:163], v[128:129]
    v_pk_mul_f32 v[164:165], v[130:131], v[130:131]
    v_pk_fma_f32 v[164:165], v[164:165], v[156:157], v[158:159]
    v_pk_mul_f32 v[164:165], v[164:165], v[130:131]
    v_exp_f32 v162, v162
    v_exp_f32 v163, v163
    v_exp_f32 v164, v164
    v_exp_f32 v165, v165
    v_pk_add_f32 v[162:163], v[162:163], v[160:161]
    v_pk_add_f32 v[164:165], v[164:165], v[160:161]
    v_rcp_f32 v162, v162
    v_rcp_f32 v163, v163
    v_rcp_f32 v164, v164
    v_rcp_f32 v165, v165
    v_pk_mul_f32 v[128:129], v[128:129], v[162:163]
    v_pk_mul_f32 v[130:131], v[130:131], v[164:165]
    v_cvt_pk_bf16_f32 v152, v128, v129
    v_cvt_pk_bf16_f32 v153, v130, v131
    buffer_store_dwordx2 v[152:153], v147, s[16:19], s68 offen
    v_pk_mul_f32 v[162:163], v[4:5], v[4:5]
    v_pk_fma_f32 v[162:163], v[162:163], v[156:157], v[158:159]
    v_pk_mul_f32 v[162:163], v[162:163], v[4:5]
    v_pk_mul_f32 v[164:165], v[6:7], v[6:7]
    v_pk_fma_f32 v[164:165], v[164:165], v[156:157], v[158:159]
    v_pk_mul_f32 v[164:165], v[164:165], v[6:7]
    v_exp_f32 v162, v162
    v_exp_f32 v163, v163
    v_exp_f32 v164, v164
    v_exp_f32 v165, v165
    v_pk_add_f32 v[162:163], v[162:163], v[160:161]
    v_pk_add_f32 v[164:165], v[164:165], v[160:161]
    v_rcp_f32 v162, v162
    v_rcp_f32 v163, v163
    v_rcp_f32 v164, v164
    v_rcp_f32 v165, v165
    v_pk_mul_f32 v[4:5], v[4:5], v[162:163]
    v_pk_mul_f32 v[6:7], v[6:7], v[164:165]
    v_cvt_pk_bf16_f32 v152, v4, v5
    v_cvt_pk_bf16_f32 v153, v6, v7
    v_pk_mul_f32 v[162:163], v[20:21], v[20:21]
    v_pk_fma_f32 v[162:163], v[162:163], v[156:157], v[158:159]
    v_pk_mul_f32 v[162:163], v[162:163], v[20:21]
    v_pk_mul_f32 v[164:165], v[22:23], v[22:23]
    v_pk_fma_f32 v[164:165], v[164:165], v[156:157], v[158:159]
    v_pk_mul_f32 v[164:165], v[164:165], v[22:23]
    v_exp_f32 v162, v162
    v_exp_f32 v163, v163
    v_exp_f32 v164, v164
    v_exp_f32 v165, v165
    v_pk_add_f32 v[162:163], v[162:163], v[160:161]
    v_pk_add_f32 v[164:165], v[164:165], v[160:161]
    v_rcp_f32 v162, v162
    v_rcp_f32 v163, v163
    v_rcp_f32 v164, v164
    v_rcp_f32 v165, v165
    v_pk_mul_f32 v[20:21], v[20:21], v[162:163]
    v_pk_mul_f32 v[22:23], v[22:23], v[164:165]
    v_cvt_pk_bf16_f32 v154, v20, v21
    v_cvt_pk_bf16_f32 v155, v22, v23
    s_nop 0
    v_permlane16_swap_b32 v152, v154
    s_nop 0
    v_permlane16_swap_b32 v153, v155
    buffer_store_dwordx4 v[152:155], v146, s[16:19], s65 offen offset:0
    v_pk_mul_f32 v[162:163], v[36:37], v[36:37]
    v_pk_fma_f32 v[162:163], v[162:163], v[156:157], v[158:159]
    v_pk_mul_f32 v[162:163], v[162:163], v[36:37]
    v_pk_mul_f32 v[164:165], v[38:39], v[38:39]
    v_pk_fma_f32 v[164:165], v[164:165], v[156:157], v[158:159]
    v_pk_mul_f32 v[164:165], v[164:165], v[38:39]
    v_exp_f32 v162, v162
    v_exp_f32 v163, v163
    v_exp_f32 v164, v164
    v_exp_f32 v165, v165
    v_pk_add_f32 v[162:163], v[162:163], v[160:161]
    v_pk_add_f32 v[164:165], v[164:165], v[160:161]
    v_rcp_f32 v162, v162
    v_rcp_f32 v163, v163
    v_rcp_f32 v164, v164
    v_rcp_f32 v165, v165
    v_pk_mul_f32 v[36:37], v[36:37], v[162:163]
    v_pk_mul_f32 v[38:39], v[38:39], v[164:165]
    v_cvt_pk_bf16_f32 v152, v36, v37
    v_cvt_pk_bf16_f32 v153, v38, v39
    v_pk_mul_f32 v[162:163], v[52:53], v[52:53]
    v_pk_fma_f32 v[162:163], v[162:163], v[156:157], v[158:159]
    v_pk_mul_f32 v[162:163], v[162:163], v[52:53]
    v_pk_mul_f32 v[164:165], v[54:55], v[54:55]
    v_pk_fma_f32 v[164:165], v[164:165], v[156:157], v[158:159]
    v_pk_mul_f32 v[164:165], v[164:165], v[54:55]
    v_exp_f32 v162, v162
    v_exp_f32 v163, v163
    v_exp_f32 v164, v164
    v_exp_f32 v165, v165
    v_pk_add_f32 v[162:163], v[162:163], v[160:161]
    v_pk_add_f32 v[164:165], v[164:165], v[160:161]
    v_rcp_f32 v162, v162
    v_rcp_f32 v163, v163
    v_rcp_f32 v164, v164
    v_rcp_f32 v165, v165
    v_pk_mul_f32 v[52:53], v[52:53], v[162:163]
    v_pk_mul_f32 v[54:55], v[54:55], v[164:165]
    v_cvt_pk_bf16_f32 v154, v52, v53
    v_cvt_pk_bf16_f32 v155, v54, v55
    s_nop 0
    v_permlane16_swap_b32 v152, v154
    s_nop 0
    v_permlane16_swap_b32 v153, v155
    buffer_store_dwordx4 v[152:155], v146, s[16:19], s65 offen offset:1024
    v_pk_mul_f32 v[162:163], v[68:69], v[68:69]
    v_pk_fma_f32 v[162:163], v[162:163], v[156:157], v[158:159]
    v_pk_mul_f32 v[162:163], v[162:163], v[68:69]
    v_pk_mul_f32 v[164:165], v[70:71], v[70:71]
    v_pk_fma_f32 v[164:165], v[164:165], v[156:157], v[158:159]
    v_pk_mul_f32 v[164:165], v[164:165], v[70:71]
    v_exp_f32 v162, v162
    v_exp_f32 v163, v163
    v_exp_f32 v164, v164
    v_exp_f32 v165, v165
    v_pk_add_f32 v[162:163], v[162:163], v[160:161]
    v_pk_add_f32 v[164:165], v[164:165], v[160:161]
    v_rcp_f32 v162, v162
    v_rcp_f32 v163, v163
    v_rcp_f32 v164, v164
    v_rcp_f32 v165, v165
    v_pk_mul_f32 v[68:69], v[68:69], v[162:163]
    v_pk_mul_f32 v[70:71], v[70:71], v[164:165]
    v_cvt_pk_bf16_f32 v152, v68, v69
    v_cvt_pk_bf16_f32 v153, v70, v71
    v_pk_mul_f32 v[162:163], v[84:85], v[84:85]
    v_pk_fma_f32 v[162:163], v[162:163], v[156:157], v[158:159]
    v_pk_mul_f32 v[162:163], v[162:163], v[84:85]
    v_pk_mul_f32 v[164:165], v[86:87], v[86:87]
    v_pk_fma_f32 v[164:165], v[164:165], v[156:157], v[158:159]
    v_pk_mul_f32 v[164:165], v[164:165], v[86:87]
    v_exp_f32 v162, v162
    v_exp_f32 v163, v163
    v_exp_f32 v164, v164
    v_exp_f32 v165, v165
    v_pk_add_f32 v[162:163], v[162:163], v[160:161]
    v_pk_add_f32 v[164:165], v[164:165], v[160:161]
    v_rcp_f32 v162, v162
    v_rcp_f32 v163, v163
    v_rcp_f32 v164, v164
    v_rcp_f32 v165, v165
    v_pk_mul_f32 v[84:85], v[84:85], v[162:163]
    v_pk_mul_f32 v[86:87], v[86:87], v[164:165]
    v_cvt_pk_bf16_f32 v154, v84, v85
    v_cvt_pk_bf16_f32 v155, v86, v87
    s_nop 0
    v_permlane16_swap_b32 v152, v154
    s_nop 0
    v_permlane16_swap_b32 v153, v155
    buffer_store_dwordx4 v[152:155], v146, s[16:19], s65 offen offset:2048
    v_pk_mul_f32 v[162:163], v[100:101], v[100:101]
    v_pk_fma_f32 v[162:163], v[162:163], v[156:157], v[158:159]
    v_pk_mul_f32 v[162:163], v[162:163], v[100:101]
    v_pk_mul_f32 v[164:165], v[102:103], v[102:103]
    v_pk_fma_f32 v[164:165], v[164:165], v[156:157], v[158:159]
    v_pk_mul_f32 v[164:165], v[164:165], v[102:103]
    v_exp_f32 v162, v162
    v_exp_f32 v163, v163
    v_exp_f32 v164, v164
    v_exp_f32 v165, v165
    v_pk_add_f32 v[162:163], v[162:163], v[160:161]
    v_pk_add_f32 v[164:165], v[164:165], v[160:161]
    v_rcp_f32 v162, v162
    v_rcp_f32 v163, v163
    v_rcp_f32 v164, v164
    v_rcp_f32 v165, v165
    v_pk_mul_f32 v[100:101], v[100:101], v[162:163]
    v_pk_mul_f32 v[102:103], v[102:103], v[164:165]
    v_cvt_pk_bf16_f32 v152, v100, v101
    v_cvt_pk_bf16_f32 v153, v102, v103
    v_pk_mul_f32 v[162:163], v[116:117], v[116:117]
    v_pk_fma_f32 v[162:163], v[162:163], v[156:157], v[158:159]
    v_pk_mul_f32 v[162:163], v[162:163], v[116:117]
    v_pk_mul_f32 v[164:165], v[118:119], v[118:119]
    v_pk_fma_f32 v[164:165], v[164:165], v[156:157], v[158:159]
    v_pk_mul_f32 v[164:165], v[164:165], v[118:119]
    v_exp_f32 v162, v162
    v_exp_f32 v163, v163
    v_exp_f32 v164, v164
    v_exp_f32 v165, v165
    v_pk_add_f32 v[162:163], v[162:163], v[160:161]
    v_pk_add_f32 v[164:165], v[164:165], v[160:161]
    v_rcp_f32 v162, v162
    v_rcp_f32 v163, v163
    v_rcp_f32 v164, v164
    v_rcp_f32 v165, v165
    v_pk_mul_f32 v[116:117], v[116:117], v[162:163]
    v_pk_mul_f32 v[118:119], v[118:119], v[164:165]
    v_cvt_pk_bf16_f32 v154, v116, v117
    v_cvt_pk_bf16_f32 v155, v118, v119
    s_nop 0
    v_permlane16_swap_b32 v152, v154
    s_nop 0
    v_permlane16_swap_b32 v153, v155
    buffer_store_dwordx4 v[152:155], v146, s[16:19], s65 offen offset:3072
    v_pk_mul_f32 v[162:163], v[132:133], v[132:133]
    v_pk_fma_f32 v[162:163], v[162:163], v[156:157], v[158:159]
    v_pk_mul_f32 v[162:163], v[162:163], v[132:133]
    v_pk_mul_f32 v[164:165], v[134:135], v[134:135]
    v_pk_fma_f32 v[164:165], v[164:165], v[156:157], v[158:159]
    v_pk_mul_f32 v[164:165], v[164:165], v[134:135]
    v_exp_f32 v162, v162
    v_exp_f32 v163, v163
    v_exp_f32 v164, v164
    v_exp_f32 v165, v165
    v_pk_add_f32 v[162:163], v[162:163], v[160:161]
    v_pk_add_f32 v[164:165], v[164:165], v[160:161]
    v_rcp_f32 v162, v162
    v_rcp_f32 v163, v163
    v_rcp_f32 v164, v164
    v_rcp_f32 v165, v165
    v_pk_mul_f32 v[132:133], v[132:133], v[162:163]
    v_pk_mul_f32 v[134:135], v[134:135], v[164:165]
    v_cvt_pk_bf16_f32 v152, v132, v133
    v_cvt_pk_bf16_f32 v153, v134, v135
    buffer_store_dwordx2 v[152:153], v147, s[16:19], s69 offen
    v_pk_mul_f32 v[162:163], v[8:9], v[8:9]
    v_pk_fma_f32 v[162:163], v[162:163], v[156:157], v[158:159]
    v_pk_mul_f32 v[162:163], v[162:163], v[8:9]
    v_pk_mul_f32 v[164:165], v[10:11], v[10:11]
    v_pk_fma_f32 v[164:165], v[164:165], v[156:157], v[158:159]
    v_pk_mul_f32 v[164:165], v[164:165], v[10:11]
    v_exp_f32 v162, v162
    v_exp_f32 v163, v163
    v_exp_f32 v164, v164
    v_exp_f32 v165, v165
    v_pk_add_f32 v[162:163], v[162:163], v[160:161]
    v_pk_add_f32 v[164:165], v[164:165], v[160:161]
    v_rcp_f32 v162, v162
    v_rcp_f32 v163, v163
    v_rcp_f32 v164, v164
    v_rcp_f32 v165, v165
    v_pk_mul_f32 v[8:9], v[8:9], v[162:163]
    v_pk_mul_f32 v[10:11], v[10:11], v[164:165]
    v_cvt_pk_bf16_f32 v152, v8, v9
    v_cvt_pk_bf16_f32 v153, v10, v11
    v_pk_mul_f32 v[162:163], v[24:25], v[24:25]
    v_pk_fma_f32 v[162:163], v[162:163], v[156:157], v[158:159]
    v_pk_mul_f32 v[162:163], v[162:163], v[24:25]
    v_pk_mul_f32 v[164:165], v[26:27], v[26:27]
    v_pk_fma_f32 v[164:165], v[164:165], v[156:157], v[158:159]
    v_pk_mul_f32 v[164:165], v[164:165], v[26:27]
    v_exp_f32 v162, v162
    v_exp_f32 v163, v163
    v_exp_f32 v164, v164
    v_exp_f32 v165, v165
    v_pk_add_f32 v[162:163], v[162:163], v[160:161]
    v_pk_add_f32 v[164:165], v[164:165], v[160:161]
    v_rcp_f32 v162, v162
    v_rcp_f32 v163, v163
    v_rcp_f32 v164, v164
    v_rcp_f32 v165, v165
    v_pk_mul_f32 v[24:25], v[24:25], v[162:163]
    v_pk_mul_f32 v[26:27], v[26:27], v[164:165]
    v_cvt_pk_bf16_f32 v154, v24, v25
    v_cvt_pk_bf16_f32 v155, v26, v27
    s_nop 0
    v_permlane16_swap_b32 v152, v154
    s_nop 0
    v_permlane16_swap_b32 v153, v155
    buffer_store_dwordx4 v[152:155], v146, s[16:19], s66 offen offset:0
    v_pk_mul_f32 v[162:163], v[40:41], v[40:41]
    v_pk_fma_f32 v[162:163], v[162:163], v[156:157], v[158:159]
    v_pk_mul_f32 v[162:163], v[162:163], v[40:41]
    v_pk_mul_f32 v[164:165], v[42:43], v[42:43]
    v_pk_fma_f32 v[164:165], v[164:165], v[156:157], v[158:159]
    v_pk_mul_f32 v[164:165], v[164:165], v[42:43]
    v_exp_f32 v162, v162
    v_exp_f32 v163, v163
    v_exp_f32 v164, v164
    v_exp_f32 v165, v165
    v_pk_add_f32 v[162:163], v[162:163], v[160:161]
    v_pk_add_f32 v[164:165], v[164:165], v[160:161]
    v_rcp_f32 v162, v162
    v_rcp_f32 v163, v163
    v_rcp_f32 v164, v164
    v_rcp_f32 v165, v165
    v_pk_mul_f32 v[40:41], v[40:41], v[162:163]
    v_pk_mul_f32 v[42:43], v[42:43], v[164:165]
    v_cvt_pk_bf16_f32 v152, v40, v41
    v_cvt_pk_bf16_f32 v153, v42, v43
    v_pk_mul_f32 v[162:163], v[56:57], v[56:57]
    v_pk_fma_f32 v[162:163], v[162:163], v[156:157], v[158:159]
    v_pk_mul_f32 v[162:163], v[162:163], v[56:57]
    v_pk_mul_f32 v[164:165], v[58:59], v[58:59]
    v_pk_fma_f32 v[164:165], v[164:165], v[156:157], v[158:159]
    v_pk_mul_f32 v[164:165], v[164:165], v[58:59]
    v_exp_f32 v162, v162
    v_exp_f32 v163, v163
    v_exp_f32 v164, v164
    v_exp_f32 v165, v165
    v_pk_add_f32 v[162:163], v[162:163], v[160:161]
    v_pk_add_f32 v[164:165], v[164:165], v[160:161]
    v_rcp_f32 v162, v162
    v_rcp_f32 v163, v163
    v_rcp_f32 v164, v164
    v_rcp_f32 v165, v165
    v_pk_mul_f32 v[56:57], v[56:57], v[162:163]
    v_pk_mul_f32 v[58:59], v[58:59], v[164:165]
    v_cvt_pk_bf16_f32 v154, v56, v57
    v_cvt_pk_bf16_f32 v155, v58, v59
    s_nop 0
    v_permlane16_swap_b32 v152, v154
    s_nop 0
    v_permlane16_swap_b32 v153, v155
    buffer_store_dwordx4 v[152:155], v146, s[16:19], s66 offen offset:1024
    v_pk_mul_f32 v[162:163], v[72:73], v[72:73]
    v_pk_fma_f32 v[162:163], v[162:163], v[156:157], v[158:159]
    v_pk_mul_f32 v[162:163], v[162:163], v[72:73]
    v_pk_mul_f32 v[164:165], v[74:75], v[74:75]
    v_pk_fma_f32 v[164:165], v[164:165], v[156:157], v[158:159]
    v_pk_mul_f32 v[164:165], v[164:165], v[74:75]
    v_exp_f32 v162, v162
    v_exp_f32 v163, v163
    v_exp_f32 v164, v164
    v_exp_f32 v165, v165
    v_pk_add_f32 v[162:163], v[162:163], v[160:161]
    v_pk_add_f32 v[164:165], v[164:165], v[160:161]
    v_rcp_f32 v162, v162
    v_rcp_f32 v163, v163
    v_rcp_f32 v164, v164
    v_rcp_f32 v165, v165
    v_pk_mul_f32 v[72:73], v[72:73], v[162:163]
    v_pk_mul_f32 v[74:75], v[74:75], v[164:165]
    v_cvt_pk_bf16_f32 v152, v72, v73
    v_cvt_pk_bf16_f32 v153, v74, v75
    v_pk_mul_f32 v[162:163], v[88:89], v[88:89]
    v_pk_fma_f32 v[162:163], v[162:163], v[156:157], v[158:159]
    v_pk_mul_f32 v[162:163], v[162:163], v[88:89]
    v_pk_mul_f32 v[164:165], v[90:91], v[90:91]
    v_pk_fma_f32 v[164:165], v[164:165], v[156:157], v[158:159]
    v_pk_mul_f32 v[164:165], v[164:165], v[90:91]
    v_exp_f32 v162, v162
    v_exp_f32 v163, v163
    v_exp_f32 v164, v164
    v_exp_f32 v165, v165
    v_pk_add_f32 v[162:163], v[162:163], v[160:161]
    v_pk_add_f32 v[164:165], v[164:165], v[160:161]
    v_rcp_f32 v162, v162
    v_rcp_f32 v163, v163
    v_rcp_f32 v164, v164
    v_rcp_f32 v165, v165
    v_pk_mul_f32 v[88:89], v[88:89], v[162:163]
    v_pk_mul_f32 v[90:91], v[90:91], v[164:165]
    v_cvt_pk_bf16_f32 v154, v88, v89
    v_cvt_pk_bf16_f32 v155, v90, v91
    s_nop 0
    v_permlane16_swap_b32 v152, v154
    s_nop 0
    v_permlane16_swap_b32 v153, v155
    buffer_store_dwordx4 v[152:155], v146, s[16:19], s66 offen offset:2048
    v_pk_mul_f32 v[162:163], v[104:105], v[104:105]
    v_pk_fma_f32 v[162:163], v[162:163], v[156:157], v[158:159]
    v_pk_mul_f32 v[162:163], v[162:163], v[104:105]
    v_pk_mul_f32 v[164:165], v[106:107], v[106:107]
    v_pk_fma_f32 v[164:165], v[164:165], v[156:157], v[158:159]
    v_pk_mul_f32 v[164:165], v[164:165], v[106:107]
    v_exp_f32 v162, v162
    v_exp_f32 v163, v163
    v_exp_f32 v164, v164
    v_exp_f32 v165, v165
    v_pk_add_f32 v[162:163], v[162:163], v[160:161]
    v_pk_add_f32 v[164:165], v[164:165], v[160:161]
    v_rcp_f32 v162, v162
    v_rcp_f32 v163, v163
    v_rcp_f32 v164, v164
    v_rcp_f32 v165, v165
    v_pk_mul_f32 v[104:105], v[104:105], v[162:163]
    v_pk_mul_f32 v[106:107], v[106:107], v[164:165]
    v_cvt_pk_bf16_f32 v152, v104, v105
    v_cvt_pk_bf16_f32 v153, v106, v107
    v_pk_mul_f32 v[162:163], v[120:121], v[120:121]
    v_pk_fma_f32 v[162:163], v[162:163], v[156:157], v[158:159]
    v_pk_mul_f32 v[162:163], v[162:163], v[120:121]
    v_pk_mul_f32 v[164:165], v[122:123], v[122:123]
    v_pk_fma_f32 v[164:165], v[164:165], v[156:157], v[158:159]
    v_pk_mul_f32 v[164:165], v[164:165], v[122:123]
    v_exp_f32 v162, v162
    v_exp_f32 v163, v163
    v_exp_f32 v164, v164
    v_exp_f32 v165, v165
    v_pk_add_f32 v[162:163], v[162:163], v[160:161]
    v_pk_add_f32 v[164:165], v[164:165], v[160:161]
    v_rcp_f32 v162, v162
    v_rcp_f32 v163, v163
    v_rcp_f32 v164, v164
    v_rcp_f32 v165, v165
    v_pk_mul_f32 v[120:121], v[120:121], v[162:163]
    v_pk_mul_f32 v[122:123], v[122:123], v[164:165]
    v_cvt_pk_bf16_f32 v154, v120, v121
    v_cvt_pk_bf16_f32 v155, v122, v123
    s_nop 0
    v_permlane16_swap_b32 v152, v154
    s_nop 0
    v_permlane16_swap_b32 v153, v155
    buffer_store_dwordx4 v[152:155], v146, s[16:19], s66 offen offset:3072
    v_pk_mul_f32 v[162:163], v[136:137], v[136:137]
    v_pk_fma_f32 v[162:163], v[162:163], v[156:157], v[158:159]
    v_pk_mul_f32 v[162:163], v[162:163], v[136:137]
    v_pk_mul_f32 v[164:165], v[138:139], v[138:139]
    v_pk_fma_f32 v[164:165], v[164:165], v[156:157], v[158:159]
    v_pk_mul_f32 v[164:165], v[164:165], v[138:139]
    v_exp_f32 v162, v162
    v_exp_f32 v163, v163
    v_exp_f32 v164, v164
    v_exp_f32 v165, v165
    v_pk_add_f32 v[162:163], v[162:163], v[160:161]
    v_pk_add_f32 v[164:165], v[164:165], v[160:161]
    v_rcp_f32 v162, v162
    v_rcp_f32 v163, v163
    v_rcp_f32 v164, v164
    v_rcp_f32 v165, v165
    v_pk_mul_f32 v[136:137], v[136:137], v[162:163]
    v_pk_mul_f32 v[138:139], v[138:139], v[164:165]
    v_cvt_pk_bf16_f32 v152, v136, v137
    v_cvt_pk_bf16_f32 v153, v138, v139
    buffer_store_dwordx2 v[152:153], v147, s[16:19], s70 offen
    v_pk_mul_f32 v[162:163], v[12:13], v[12:13]
    v_pk_fma_f32 v[162:163], v[162:163], v[156:157], v[158:159]
    v_pk_mul_f32 v[162:163], v[162:163], v[12:13]
    v_pk_mul_f32 v[164:165], v[14:15], v[14:15]
    v_pk_fma_f32 v[164:165], v[164:165], v[156:157], v[158:159]
    v_pk_mul_f32 v[164:165], v[164:165], v[14:15]
    v_exp_f32 v162, v162
    v_exp_f32 v163, v163
    v_exp_f32 v164, v164
    v_exp_f32 v165, v165
    v_pk_add_f32 v[162:163], v[162:163], v[160:161]
    v_pk_add_f32 v[164:165], v[164:165], v[160:161]
    v_rcp_f32 v162, v162
    v_rcp_f32 v163, v163
    v_rcp_f32 v164, v164
    v_rcp_f32 v165, v165
    v_pk_mul_f32 v[12:13], v[12:13], v[162:163]
    v_pk_mul_f32 v[14:15], v[14:15], v[164:165]
    v_cvt_pk_bf16_f32 v152, v12, v13
    v_cvt_pk_bf16_f32 v153, v14, v15
    v_pk_mul_f32 v[162:163], v[28:29], v[28:29]
    v_pk_fma_f32 v[162:163], v[162:163], v[156:157], v[158:159]
    v_pk_mul_f32 v[162:163], v[162:163], v[28:29]
    v_pk_mul_f32 v[164:165], v[30:31], v[30:31]
    v_pk_fma_f32 v[164:165], v[164:165], v[156:157], v[158:159]
    v_pk_mul_f32 v[164:165], v[164:165], v[30:31]
    v_exp_f32 v162, v162
    v_exp_f32 v163, v163
    v_exp_f32 v164, v164
    v_exp_f32 v165, v165
    v_pk_add_f32 v[162:163], v[162:163], v[160:161]
    v_pk_add_f32 v[164:165], v[164:165], v[160:161]
    v_rcp_f32 v162, v162
    v_rcp_f32 v163, v163
    v_rcp_f32 v164, v164
    v_rcp_f32 v165, v165
    v_pk_mul_f32 v[28:29], v[28:29], v[162:163]
    v_pk_mul_f32 v[30:31], v[30:31], v[164:165]
    v_cvt_pk_bf16_f32 v154, v28, v29
    v_cvt_pk_bf16_f32 v155, v30, v31
    s_nop 0
    v_permlane16_swap_b32 v152, v154
    s_nop 0
    v_permlane16_swap_b32 v153, v155
    buffer_store_dwordx4 v[152:155], v146, s[16:19], s67 offen offset:0
    v_pk_mul_f32 v[162:163], v[44:45], v[44:45]
    v_pk_fma_f32 v[162:163], v[162:163], v[156:157], v[158:159]
    v_pk_mul_f32 v[162:163], v[162:163], v[44:45]
    v_pk_mul_f32 v[164:165], v[46:47], v[46:47]
    v_pk_fma_f32 v[164:165], v[164:165], v[156:157], v[158:159]
    v_pk_mul_f32 v[164:165], v[164:165], v[46:47]
    v_exp_f32 v162, v162
    v_exp_f32 v163, v163
    v_exp_f32 v164, v164
    v_exp_f32 v165, v165
    v_pk_add_f32 v[162:163], v[162:163], v[160:161]
    v_pk_add_f32 v[164:165], v[164:165], v[160:161]
    v_rcp_f32 v162, v162
    v_rcp_f32 v163, v163
    v_rcp_f32 v164, v164
    v_rcp_f32 v165, v165
    v_pk_mul_f32 v[44:45], v[44:45], v[162:163]
    v_pk_mul_f32 v[46:47], v[46:47], v[164:165]
    v_cvt_pk_bf16_f32 v152, v44, v45
    v_cvt_pk_bf16_f32 v153, v46, v47
    v_pk_mul_f32 v[162:163], v[60:61], v[60:61]
    v_pk_fma_f32 v[162:163], v[162:163], v[156:157], v[158:159]
    v_pk_mul_f32 v[162:163], v[162:163], v[60:61]
    v_pk_mul_f32 v[164:165], v[62:63], v[62:63]
    v_pk_fma_f32 v[164:165], v[164:165], v[156:157], v[158:159]
    v_pk_mul_f32 v[164:165], v[164:165], v[62:63]
    v_exp_f32 v162, v162
    v_exp_f32 v163, v163
    v_exp_f32 v164, v164
    v_exp_f32 v165, v165
    v_pk_add_f32 v[162:163], v[162:163], v[160:161]
    v_pk_add_f32 v[164:165], v[164:165], v[160:161]
    v_rcp_f32 v162, v162
    v_rcp_f32 v163, v163
    v_rcp_f32 v164, v164
    v_rcp_f32 v165, v165
    v_pk_mul_f32 v[60:61], v[60:61], v[162:163]
    v_pk_mul_f32 v[62:63], v[62:63], v[164:165]
    v_cvt_pk_bf16_f32 v154, v60, v61
    v_cvt_pk_bf16_f32 v155, v62, v63
    s_nop 0
    v_permlane16_swap_b32 v152, v154
    s_nop 0
    v_permlane16_swap_b32 v153, v155
    buffer_store_dwordx4 v[152:155], v146, s[16:19], s67 offen offset:1024
    v_pk_mul_f32 v[162:163], v[76:77], v[76:77]
    v_pk_fma_f32 v[162:163], v[162:163], v[156:157], v[158:159]
    v_pk_mul_f32 v[162:163], v[162:163], v[76:77]
    v_pk_mul_f32 v[164:165], v[78:79], v[78:79]
    v_pk_fma_f32 v[164:165], v[164:165], v[156:157], v[158:159]
    v_pk_mul_f32 v[164:165], v[164:165], v[78:79]
    v_exp_f32 v162, v162
    v_exp_f32 v163, v163
    v_exp_f32 v164, v164
    v_exp_f32 v165, v165
    v_pk_add_f32 v[162:163], v[162:163], v[160:161]
    v_pk_add_f32 v[164:165], v[164:165], v[160:161]
    v_rcp_f32 v162, v162
    v_rcp_f32 v163, v163
    v_rcp_f32 v164, v164
    v_rcp_f32 v165, v165
    v_pk_mul_f32 v[76:77], v[76:77], v[162:163]
    v_pk_mul_f32 v[78:79], v[78:79], v[164:165]
    v_cvt_pk_bf16_f32 v152, v76, v77
    v_cvt_pk_bf16_f32 v153, v78, v79
    v_pk_mul_f32 v[162:163], v[92:93], v[92:93]
    v_pk_fma_f32 v[162:163], v[162:163], v[156:157], v[158:159]
    v_pk_mul_f32 v[162:163], v[162:163], v[92:93]
    v_pk_mul_f32 v[164:165], v[94:95], v[94:95]
    v_pk_fma_f32 v[164:165], v[164:165], v[156:157], v[158:159]
    v_pk_mul_f32 v[164:165], v[164:165], v[94:95]
    v_exp_f32 v162, v162
    v_exp_f32 v163, v163
    v_exp_f32 v164, v164
    v_exp_f32 v165, v165
    v_pk_add_f32 v[162:163], v[162:163], v[160:161]
    v_pk_add_f32 v[164:165], v[164:165], v[160:161]
    v_rcp_f32 v162, v162
    v_rcp_f32 v163, v163
    v_rcp_f32 v164, v164
    v_rcp_f32 v165, v165
    v_pk_mul_f32 v[92:93], v[92:93], v[162:163]
    v_pk_mul_f32 v[94:95], v[94:95], v[164:165]
    v_cvt_pk_bf16_f32 v154, v92, v93
    v_cvt_pk_bf16_f32 v155, v94, v95
    s_nop 0
    v_permlane16_swap_b32 v152, v154
    s_nop 0
    v_permlane16_swap_b32 v153, v155
    buffer_store_dwordx4 v[152:155], v146, s[16:19], s67 offen offset:2048
    v_pk_mul_f32 v[162:163], v[108:109], v[108:109]
    v_pk_fma_f32 v[162:163], v[162:163], v[156:157], v[158:159]
    v_pk_mul_f32 v[162:163], v[162:163], v[108:109]
    v_pk_mul_f32 v[164:165], v[110:111], v[110:111]
    v_pk_fma_f32 v[164:165], v[164:165], v[156:157], v[158:159]
    v_pk_mul_f32 v[164:165], v[164:165], v[110:111]
    v_exp_f32 v162, v162
    v_exp_f32 v163, v163
    v_exp_f32 v164, v164
    v_exp_f32 v165, v165
    v_pk_add_f32 v[162:163], v[162:163], v[160:161]
    v_pk_add_f32 v[164:165], v[164:165], v[160:161]
    v_rcp_f32 v162, v162
    v_rcp_f32 v163, v163
    v_rcp_f32 v164, v164
    v_rcp_f32 v165, v165
    v_pk_mul_f32 v[108:109], v[108:109], v[162:163]
    v_pk_mul_f32 v[110:111], v[110:111], v[164:165]
    v_cvt_pk_bf16_f32 v152, v108, v109
    v_cvt_pk_bf16_f32 v153, v110, v111
    v_pk_mul_f32 v[162:163], v[124:125], v[124:125]
    v_pk_fma_f32 v[162:163], v[162:163], v[156:157], v[158:159]
    v_pk_mul_f32 v[162:163], v[162:163], v[124:125]
    v_pk_mul_f32 v[164:165], v[126:127], v[126:127]
    v_pk_fma_f32 v[164:165], v[164:165], v[156:157], v[158:159]
    v_pk_mul_f32 v[164:165], v[164:165], v[126:127]
    v_exp_f32 v162, v162
    v_exp_f32 v163, v163
    v_exp_f32 v164, v164
    v_exp_f32 v165, v165
    v_pk_add_f32 v[162:163], v[162:163], v[160:161]
    v_pk_add_f32 v[164:165], v[164:165], v[160:161]
    v_rcp_f32 v162, v162
    v_rcp_f32 v163, v163
    v_rcp_f32 v164, v164
    v_rcp_f32 v165, v165
    v_pk_mul_f32 v[124:125], v[124:125], v[162:163]
    v_pk_mul_f32 v[126:127], v[126:127], v[164:165]
    v_cvt_pk_bf16_f32 v154, v124, v125
    v_cvt_pk_bf16_f32 v155, v126, v127
    s_nop 0
    v_permlane16_swap_b32 v152, v154
    s_nop 0
    v_permlane16_swap_b32 v153, v155
    buffer_store_dwordx4 v[152:155], v146, s[16:19], s67 offen offset:3072
    v_pk_mul_f32 v[162:163], v[140:141], v[140:141]
    v_pk_fma_f32 v[162:163], v[162:163], v[156:157], v[158:159]
    v_pk_mul_f32 v[162:163], v[162:163], v[140:141]
    v_pk_mul_f32 v[164:165], v[142:143], v[142:143]
    v_pk_fma_f32 v[164:165], v[164:165], v[156:157], v[158:159]
    v_pk_mul_f32 v[164:165], v[164:165], v[142:143]
    v_exp_f32 v162, v162
    v_exp_f32 v163, v163
    v_exp_f32 v164, v164
    v_exp_f32 v165, v165
    v_pk_add_f32 v[162:163], v[162:163], v[160:161]
    v_pk_add_f32 v[164:165], v[164:165], v[160:161]
    v_rcp_f32 v162, v162
    v_rcp_f32 v163, v163
    v_rcp_f32 v164, v164
    v_rcp_f32 v165, v165
    v_pk_mul_f32 v[140:141], v[140:141], v[162:163]
    v_pk_mul_f32 v[142:143], v[142:143], v[164:165]
    v_cvt_pk_bf16_f32 v152, v140, v141
    v_cvt_pk_bf16_f32 v153, v142, v143
    buffer_store_dwordx2 v[152:153], v147, s[16:19], s71 offen
    s_waitcnt vmcnt(0) lgkmcnt(0)
    s_waitcnt lgkmcnt(0)
    s_endpgm
k2_end_6:
    s_endpgm
.globl k3_kernel
.p2align 8
.type k3_kernel,@function
k3_kernel:
    s_cmp_ge_u32 s2, 0x100
    s_cbranch_scc1 k3_end_31
    s_load_dwordx2 s[4:5], s[0:1], 64
    s_load_dwordx2 s[6:7], s[0:1], 32
    s_load_dwordx2 s[12:13], s[0:1], 0x60
    v_lshrrev_b32 v1, 6, v0
    s_nop 0
    v_readfirstlane_b32 s28, v1
    s_and_b32 s31, s2, 3
    s_lshr_b32 s30, s2, 6
    s_bfe_u32 s29, s2, 0x40002
    s_lshr_b32 s26, s28, 1
    s_and_b32 s27, s28, 1
    s_lshl_b32 s25, s31, 2
    s_add_u32 s25, s25, s26
    s_waitcnt lgkmcnt(0)
    s_mov_b32 s16, s12
    s_and_b32 s17, s13, 0xffff
    s_mov_b32 s18, 0x10000000
    s_mov_b32 s19, 0x20000
    s_mov_b32 s20, s4
    s_and_b32 s21, s5, 0xffff
    s_mov_b32 s22, 0x510000
    s_mov_b32 s23, 0x20000
    s_mov_b32 s64, s6
    s_and_b32 s65, s7, 0xffff
    s_mov_b32 s66, 0xa2000
    s_mov_b32 s67, 0x20000
    s_mul_i32 s41, s25, 9
    s_cmp_gt_u32 s25, 0
    s_addc_u32 s42, s25, 0
    s_cmp_gt_u32 s25, 8
    s_addc_u32 s42, s42, 0
    s_and_b32 s40, s25, 7
    s_cmp_eq_u32 s40, 0
    s_cselect_b32 s34, 11, 10
    s_mul_i32 s33, s41, 0x9000
    s_mul_i32 s46, s30, 0x120
    s_add_u32 s33, s33, s46
    s_mul_i32 s68, s42, 0x9000
    s_add_u32 s68, s68, s46
    s_lshl_b32 s46, s29, 7
    s_lshl_b32 s47, s27, 6
    s_add_u32 s46, s46, s47
    s_lshr_b32 s47, s46, 4
    s_mul_i32 s47, s47, 0xa2
    s_add_u32 s48, s47, s42
    s_add_u32 s48, s48, 0x90
    s_add_u32 s47, s47, s41
    s_lshl_b32 s47, s47, 10
    s_add_u32 s47, s47, 0x600000
    s_lshl_b32 s48, s48, 10
    s_add_u32 s48, s48, 0x600000
    s_add_u32 s36, s47, 0
    s_add_u32 s69, s48, 0
    s_add_u32 s37, s47, 0x28800
    s_add_u32 s70, s48, 0x28800
    s_add_u32 s38, s47, 0x51000
    s_add_u32 s71, s48, 0x51000
    s_add_u32 s39, s47, 0x79800
    s_add_u32 s72, s48, 0x79800
    v_mov_b32 v246, v0
    v_and_b32 v247, 63, v246
    v_lshlrev_b32 v241, 4, v247
    buffer_load_dwordx4 v[188:191], v241, s[16:19], s36 offen
    s_add_u32 s36, s36, 0x400
    buffer_load_dwordx4 v[192:195], v241, s[16:19], s37 offen
    s_add_u32 s37, s37, 0x400
    buffer_load_dwordx4 v[196:199], v241, s[16:19], s38 offen
    s_add_u32 s38, s38, 0x400
    buffer_load_dwordx4 v[200:203], v241, s[16:19], s39 offen
    s_add_u32 s39, s39, 0x400
    buffer_load_dwordx4 v[204:207], v241, s[16:19], s36 offen
    s_add_u32 s36, s36, 0x400
    buffer_load_dwordx4 v[208:211], v241, s[16:19], s37 offen
    s_add_u32 s37, s37, 0x400
    buffer_load_dwordx4 v[212:215], v241, s[16:19], s38 offen
    s_add_u32 s38, s38, 0x400
    buffer_load_dwordx4 v[216:219], v241, s[16:19], s39 offen
    s_add_u32 s39, s39, 0x400
    s_mul_i32 s49, s26, 0x9600
    s_mul_i32 s55, s27, 0x12c
    s_add_u32 s56, s55, 0
    v_add_u32 v248, s56, v247
    v_mul_u32_u24 v249, 0x1b0, v248
    v_lshrrev_b32 v249, 16, v249
    v_mul_u32_u24 v250, 0x98, v249
    v_sub_u32 v250, v248, v250
    v_mul_u32_u24 v251, 0xe39, v250
    v_lshrrev_b32 v251, 16, v251
    v_mul_u32_u24 v252, 18, v251
    v_sub_u32 v252, v250, v252
    v_lshl_add_u32 v251, v249, 3, v251
    v_mul_u32_u24 v251, 0x480, v251
    v_lshl_add_u32 v251, v252, 4, v251
    v_mov_b32 v252, 0x7ff00000
    v_cmp_gt_u32 vcc, 0x90, v250
    s_nop 1
    v_cndmask_b32 v236, v252, v251, vcc
    s_lshl_b32 s50, s56, 4
    s_add_u32 s50, s50, s49
    s_add_u32 s56, s55, 64
    v_add_u32 v248, s56, v247
    v_mul_u32_u24 v249, 0x1b0, v248
    v_lshrrev_b32 v249, 16, v249
    v_mul_u32_u24 v250, 0x98, v249
    v_sub_u32 v250, v248, v250
    v_mul_u32_u24 v251, 0xe39, v250
    v_lshrrev_b32 v251, 16, v251
    v_mul_u32_u24 v252, 18, v251
    v_sub_u32 v252, v250, v252
    v_lshl_add_u32 v251, v249, 3, v251
    v_mul_u32_u24 v251, 0x480, v251
    v_lshl_add_u32 v251, v252, 4, v251
    v_mov_b32 v252, 0x7ff00000
    v_cmp_gt_u32 vcc, 0x90, v250
    s_nop 1
    v_cndmask_b32 v237, v252, v251, vcc
    s_lshl_b32 s51, s56, 4
    s_add_u32 s51, s51, s49
    s_add_u32 s56, s55, 0x80
    v_add_u32 v248, s56, v247
    v_mul_u32_u24 v249, 0x1b0, v248
    v_lshrrev_b32 v249, 16, v249
    v_mul_u32_u24 v250, 0x98, v249
    v_sub_u32 v250, v248, v250
    v_mul_u32_u24 v251, 0xe39, v250
    v_lshrrev_b32 v251, 16, v251
    v_mul_u32_u24 v252, 18, v251
    v_sub_u32 v252, v250, v252
    v_lshl_add_u32 v251, v249, 3, v251
    v_mul_u32_u24 v251, 0x480, v251
    v_lshl_add_u32 v251, v252, 4, v251
    v_mov_b32 v252, 0x7ff00000
    v_cmp_gt_u32 vcc, 0x90, v250
    s_nop 1
    v_cndmask_b32 v238, v252, v251, vcc
    s_lshl_b32 s52, s56, 4
    s_add_u32 s52, s52, s49
    s_add_u32 s56, s55, 0xc0
    v_add_u32 v248, s56, v247
    v_mul_u32_u24 v249, 0x1b0, v248
    v_lshrrev_b32 v249, 16, v249
    v_mul_u32_u24 v250, 0x98, v249
    v_sub_u32 v250, v248, v250
    v_mul_u32_u24 v251, 0xe39, v250
    v_lshrrev_b32 v251, 16, v251
    v_mul_u32_u24 v252, 18, v251
    v_sub_u32 v252, v250, v252
    v_lshl_add_u32 v251, v249, 3, v251
    v_mul_u32_u24 v251, 0x480, v251
    v_lshl_add_u32 v251, v252, 4, v251
    v_mov_b32 v252, 0x7ff00000
    v_cmp_gt_u32 vcc, 0x90, v250
    s_nop 1
    v_cndmask_b32 v239, v252, v251, vcc
    s_lshl_b32 s53, s56, 4
    s_add_u32 s53, s53, s49
    s_add_u32 s56, s55, 0x100
    v_add_u32 v248, s56, v247
    v_mul_u32_u24 v249, 0x1b0, v248
    v_lshrrev_b32 v249, 16, v249
    v_mul_u32_u24 v250, 0x98, v249
    v_sub_u32 v250, v248, v250
    v_mul_u32_u24 v251, 0xe39, v250
    v_lshrrev_b32 v251, 16, v251
    v_mul_u32_u24 v252, 18, v251
    v_sub_u32 v252, v250, v252
    v_lshl_add_u32 v251, v249, 3, v251
    v_mul_u32_u24 v251, 0x480, v251
    v_lshl_add_u32 v251, v252, 4, v251
    v_mov_b32 v252, 0x7ff00000
    v_cmp_gt_u32 vcc, 0x90, v250
    s_nop 1
    v_cndmask_b32 v240, v252, v251, vcc
    s_lshl_b32 s54, s56, 4
    s_add_u32 s54, s54, s49
    v_and_b32 v248, 15, v247
    v_lshrrev_b32 v249, 4, v247
    v_lshrrev_b32 v250, 2, v248
    v_mul_u32_u24 v250, 0x120, v250
    v_mul_u32_u24 v251, 0x980, v249
    v_add_u32 v250, v250, v251
    v_and_b32 v251, 3, v247
    v_lshl_add_u32 v250, v251, 3, v250
    v_add_u32 v242, s49, v250
    s_add_u32 m0, s50, 0
    s_nop 0
    buffer_load_dwordx4 v236, s[20:23], s33 offen lds
    s_add_u32 m0, s51, 0
    s_nop 0
    buffer_load_dwordx4 v237, s[20:23], s33 offen lds
    s_add_u32 m0, s52, 0
    s_nop 0
    buffer_load_dwordx4 v238, s[20:23], s33 offen lds
    s_add_u32 m0, s53, 0
    s_nop 0
    buffer_load_dwordx4 v239, s[20:23], s33 offen lds
    s_add_u32 m0, s54, 0
    s_mov_b32 exec_hi, 0xfff
    buffer_load_dwordx4 v240, s[20:23], s33 offen lds
    s_mov_b64 exec, -1
    s_add_u32 s33, s33, 0x9000
    s_add_u32 m0, s50, 0x2580
    s_nop 0
    buffer_load_dwordx4 v236, s[20:23], s33 offen lds
    s_add_u32 m0, s51, 0x2580
    s_nop 0
    buffer_load_dwordx4 v237, s[20:23], s33 offen lds
    s_add_u32 m0, s52, 0x2580
    s_nop 0
    buffer_load_dwordx4 v238, s[20:23], s33 offen lds
    s_add_u32 m0, s53, 0x2580
    s_nop 0
    buffer_load_dwordx4 v239, s[20:23], s33 offen lds
    s_add_u32 m0, s54, 0x2580
    s_mov_b32 exec_hi, 0xfff
    buffer_load_dwordx4 v240, s[20:23], s33 offen lds
    s_mov_b64 exec, -1
    s_add_u32 s33, s33, 0x9000
    s_add_u32 m0, s50, 0x4b00
    s_nop 0
    buffer_load_dwordx4 v236, s[20:23], s33 offen lds
    s_add_u32 m0, s51, 0x4b00
    s_nop 0
    buffer_load_dwordx4 v237, s[20:23], s33 offen lds
    s_add_u32 m0, s52, 0x4b00
    s_nop 0
    buffer_load_dwordx4 v238, s[20:23], s33 offen lds
    s_add_u32 m0, s53, 0x4b00
    s_nop 0
    buffer_load_dwordx4 v239, s[20:23], s33 offen lds
    s_add_u32 m0, s54, 0x4b00
    s_mov_b32 exec_hi, 0xfff
    buffer_load_dwordx4 v240, s[20:23], s33 offen lds
    s_mov_b64 exec, -1
    s_add_u32 s33, s33, 0x9000
    s_add_u32 m0, s50, 0x7080
    s_nop 0
    buffer_load_dwordx4 v236, s[20:23], s33 offen lds
    s_add_u32 m0, s51, 0x7080
    s_nop 0
    buffer_load_dwordx4 v237, s[20:23], s33 offen lds
    s_add_u32 m0, s52, 0x7080
    s_nop 0
    buffer_load_dwordx4 v238, s[20:23], s33 offen lds
    s_add_u32 m0, s53, 0x7080
    s_nop 0
    buffer_load_dwordx4 v239, s[20:23], s33 offen lds
    s_add_u32 m0, s54, 0x7080
    s_mov_b32 exec_hi, 0xfff
    buffer_load_dwordx4 v240, s[20:23], s33 offen lds
    s_mov_b64 exec, -1
    s_add_u32 s33, s33, 0x9000
    v_mov_b32 v0, 0
    v_mov_b32 v1, 0
    v_mov_b32 v2, 0
    v_mov_b32 v3, 0
    v_mov_b32 v4, 0
    v_mov_b32 v5, 0
    v_mov_b32 v6, 0
    v_mov_b32 v7, 0
    v_mov_b32 v8, 0
    v_mov_b32 v9, 0
    v_mov_b32 v10, 0
    v_mov_b32 v11, 0
    v_mov_b32 v12, 0
    v_mov_b32 v13, 0
    v_mov_b32 v14, 0
    v_mov_b32 v15, 0
    v_mov_b32 v16, 0
    v_mov_b32 v17, 0
    v_mov_b32 v18, 0
    v_mov_b32 v19, 0
    v_mov_b32 v20, 0
    v_mov_b32 v21, 0
    v_mov_b32 v22, 0
    v_mov_b32 v23, 0
    v_mov_b32 v24, 0
    v_mov_b32 v25, 0
    v_mov_b32 v26, 0
    v_mov_b32 v27, 0
    v_mov_b32 v28, 0
    v_mov_b32 v29, 0
    v_mov_b32 v30, 0
    v_mov_b32 v31, 0
    v_mov_b32 v32, 0
    v_mov_b32 v33, 0
    v_mov_b32 v34, 0
    v_mov_b32 v35, 0
    v_mov_b32 v36, 0
    v_mov_b32 v37, 0
    v_mov_b32 v38, 0
    v_mov_b32 v39, 0
    v_mov_b32 v40, 0
    v_mov_b32 v41, 0
    v_mov_b32 v42, 0
    v_mov_b32 v43, 0
    v_mov_b32 v44, 0
    v_mov_b32 v45, 0
    v_mov_b32 v46, 0
    v_mov_b32 v47, 0
    v_mov_b32 v48, 0
    v_mov_b32 v49, 0
    v_mov_b32 v50, 0
    v_mov_b32 v51, 0
    v_mov_b32 v52, 0
    v_mov_b32 v53, 0
    v_mov_b32 v54, 0
    v_mov_b32 v55, 0
    v_mov_b32 v56, 0
    v_mov_b32 v57, 0
    v_mov_b32 v58, 0
    v_mov_b32 v59, 0
    v_mov_b32 v60, 0
    v_mov_b32 v61, 0
    v_mov_b32 v62, 0
    v_mov_b32 v63, 0
    v_mov_b32 v64, 0
    v_mov_b32 v65, 0
    v_mov_b32 v66, 0
    v_mov_b32 v67, 0
    v_mov_b32 v68, 0
    v_mov_b32 v69, 0
    v_mov_b32 v70, 0
    v_mov_b32 v71, 0
    v_mov_b32 v72, 0
    v_mov_b32 v73, 0
    v_mov_b32 v74, 0
    v_mov_b32 v75, 0
    v_mov_b32 v76, 0
    v_mov_b32 v77, 0
    v_mov_b32 v78, 0
    v_mov_b32 v79, 0
    v_mov_b32 v80, 0
    v_mov_b32 v81, 0
    v_mov_b32 v82, 0
    v_mov_b32 v83, 0
    v_mov_b32 v84, 0
    v_mov_b32 v85, 0
    v_mov_b32 v86, 0
    v_mov_b32 v87, 0
    v_mov_b32 v88, 0
    v_mov_b32 v89, 0
    v_mov_b32 v90, 0
    v_mov_b32 v91, 0
    v_mov_b32 v92, 0
    v_mov_b32 v93, 0
    v_mov_b32 v94, 0
    v_mov_b32 v95, 0
    v_mov_b32 v96, 0
    v_mov_b32 v97, 0
    v_mov_b32 v98, 0
    v_mov_b32 v99, 0
    v_mov_b32 v100, 0
    v_mov_b32 v101, 0
    v_mov_b32 v102, 0
    v_mov_b32 v103, 0
    v_mov_b32 v104, 0
    v_mov_b32 v105, 0
    v_mov_b32 v106, 0
    v_mov_b32 v107, 0
    v_mov_b32 v108, 0
    v_mov_b32 v109, 0
    v_mov_b32 v110, 0
    v_mov_b32 v111, 0
    v_mov_b32 v112, 0
    v_mov_b32 v113, 0
    v_mov_b32 v114, 0
    v_mov_b32 v115, 0
    v_mov_b32 v116, 0
    v_mov_b32 v117, 0
    v_mov_b32 v118, 0
    v_mov_b32 v119, 0
    v_mov_b32 v120, 0
    v_mov_b32 v121, 0
    v_mov_b32 v122, 0
    v_mov_b32 v123, 0
    v_mov_b32 v124, 0
    v_mov_b32 v125, 0
    v_mov_b32 v126, 0
    v_mov_b32 v127, 0
    v_mov_b32 v128, 0
    v_mov_b32 v129, 0
    v_mov_b32 v130, 0
    v_mov_b32 v131, 0
    v_mov_b32 v132, 0
    v_mov_b32 v133, 0
    v_mov_b32 v134, 0
    v_mov_b32 v135, 0
    v_mov_b32 v136, 0
    v_mov_b32 v137, 0
    v_mov_b32 v138, 0
    v_mov_b32 v139, 0
    v_mov_b32 v140, 0
    v_mov_b32 v141, 0
    v_mov_b32 v142, 0
    v_mov_b32 v143, 0
    s_waitcnt vmcnt(15)
    s_barrier
    ds_read_b64_tr_b16 v[144:145], v242 offset:0
    ds_read_b64_tr_b16 v[146:147], v242 offset:1152
    ds_read_b64_tr_b16 v[148:149], v242 offset:32
    ds_read_b64_tr_b16 v[150:151], v242 offset:1184
    ds_read_b64_tr_b16 v[152:153], v242 offset:64
    ds_read_b64_tr_b16 v[154:155], v242 offset:1216
    ds_read_b64_tr_b16 v[156:157], v242 offset:96
    ds_read_b64_tr_b16 v[158:159], v242 offset:1248
    ds_read_b64_tr_b16 v[160:161], v242 offset:128
    ds_read_b64_tr_b16 v[162:163], v242 offset:1280
    ds_read_b64_tr_b16 v[164:165], v242 offset:160
    ds_read_b64_tr_b16 v[166:167], v242 offset:1312
    ds_read_b64_tr_b16 v[168:169], v242 offset:192
    ds_read_b64_tr_b16 v[170:171], v242 offset:1344
    ds_read_b64_tr_b16 v[172:173], v242 offset:224
    ds_read_b64_tr_b16 v[174:175], v242 offset:1376
    ds_read_b64_tr_b16 v[176:177], v242 offset:256
    ds_read_b64_tr_b16 v[178:179], v242 offset:1408
    s_waitcnt vmcnt(10) lgkmcnt(0)
    s_barrier
    s_add_u32 m0, s50, 0
    s_nop 0
    buffer_load_dwordx4 v236, s[20:23], s33 offen lds
    s_add_u32 m0, s51, 0
    s_nop 0
    buffer_load_dwordx4 v237, s[20:23], s33 offen lds
    s_add_u32 m0, s52, 0
    s_nop 0
    buffer_load_dwordx4 v238, s[20:23], s33 offen lds
    s_add_u32 m0, s53, 0
    s_nop 0
    buffer_load_dwordx4 v239, s[20:23], s33 offen lds
    s_add_u32 m0, s54, 0
    s_mov_b32 exec_hi, 0xfff
    buffer_load_dwordx4 v240, s[20:23], s33 offen lds
    s_mov_b64 exec, -1
    s_add_u32 s33, s33, 0x9000
    buffer_load_dwordx4 v[220:223], v241, s[16:19], s36 offen
    s_add_u32 s36, s36, 0x400
    buffer_load_dwordx4 v[224:227], v241, s[16:19], s37 offen
    s_add_u32 s37, s37, 0x400
    buffer_load_dwordx4 v[228:231], v241, s[16:19], s38 offen
    s_add_u32 s38, s38, 0x400
    buffer_load_dwordx4 v[232:235], v241, s[16:19], s39 offen
    s_add_u32 s39, s39, 0x400
    ds_read_b64_tr_b16 v[180:181], v242 offset:9824
    ds_read_b64_tr_b16 v[182:183], v242 offset:10976
    ds_read_b64_tr_b16 v[184:185], v242 offset:9856
    ds_read_b64_tr_b16 v[186:187], v242 offset:11008
    v_mfma_f32_16x16x32_bf16 v[0:3], v[144:147], v[188:191], v[0:3]
    v_mfma_f32_16x16x32_bf16 v[4:7], v[144:147], v[192:195], v[4:7]
    v_mfma_f32_16x16x32_bf16 v[8:11], v[144:147], v[196:199], v[8:11]
    v_mfma_f32_16x16x32_bf16 v[12:15], v[144:147], v[200:203], v[12:15]
    ds_read_b64_tr_b16 v[144:145], v242 offset:9600
    ds_read_b64_tr_b16 v[146:147], v242 offset:10752
    v_mfma_f32_16x16x32_bf16 v[16:19], v[148:151], v[188:191], v[16:19]
    v_mfma_f32_16x16x32_bf16 v[20:23], v[148:151], v[192:195], v[20:23]
    v_mfma_f32_16x16x32_bf16 v[24:27], v[148:151], v[196:199], v[24:27]
    v_mfma_f32_16x16x32_bf16 v[28:31], v[148:151], v[200:203], v[28:31]
    ds_read_b64_tr_b16 v[148:149], v242 offset:9632
    ds_read_b64_tr_b16 v[150:151], v242 offset:10784
    v_mfma_f32_16x16x32_bf16 v[32:35], v[152:155], v[188:191], v[32:35]
    v_mfma_f32_16x16x32_bf16 v[36:39], v[152:155], v[192:195], v[36:39]
    v_mfma_f32_16x16x32_bf16 v[40:43], v[152:155], v[196:199], v[40:43]
    v_mfma_f32_16x16x32_bf16 v[44:47], v[152:155], v[200:203], v[44:47]
    ds_read_b64_tr_b16 v[152:153], v242 offset:9664
    ds_read_b64_tr_b16 v[154:155], v242 offset:10816
    v_mfma_f32_16x16x32_bf16 v[48:51], v[156:159], v[188:191], v[48:51]
    v_mfma_f32_16x16x32_bf16 v[52:55], v[156:159], v[192:195], v[52:55]
    v_mfma_f32_16x16x32_bf16 v[56:59], v[156:159], v[196:199], v[56:59]
    v_mfma_f32_16x16x32_bf16 v[60:63], v[156:159], v[200:203], v[60:63]
    ds_read_b64_tr_b16 v[156:157], v242 offset:9696
    ds_read_b64_tr_b16 v[158:159], v242 offset:10848
    v_mfma_f32_16x16x32_bf16 v[64:67], v[160:163], v[188:191], v[64:67]
    v_mfma_f32_16x16x32_bf16 v[68:71], v[160:163], v[192:195], v[68:71]
    v_mfma_f32_16x16x32_bf16 v[72:75], v[160:163], v[196:199], v[72:75]
    v_mfma_f32_16x16x32_bf16 v[76:79], v[160:163], v[200:203], v[76:79]
    ds_read_b64_tr_b16 v[160:161], v242 offset:9728
    ds_read_b64_tr_b16 v[162:163], v242 offset:10880
    v_mfma_f32_16x16x32_bf16 v[80:83], v[164:167], v[188:191], v[80:83]
    v_mfma_f32_16x16x32_bf16 v[84:87], v[164:167], v[192:195], v[84:87]
    v_mfma_f32_16x16x32_bf16 v[88:91], v[164:167], v[196:199], v[88:91]
    v_mfma_f32_16x16x32_bf16 v[92:95], v[164:167], v[200:203], v[92:95]
    ds_read_b64_tr_b16 v[164:165], v242 offset:9760
    ds_read_b64_tr_b16 v[166:167], v242 offset:10912
    v_mfma_f32_16x16x32_bf16 v[96:99], v[168:171], v[188:191], v[96:99]
    v_mfma_f32_16x16x32_bf16 v[100:103], v[168:171], v[192:195], v[100:103]
    v_mfma_f32_16x16x32_bf16 v[104:107], v[168:171], v[196:199], v[104:107]
    v_mfma_f32_16x16x32_bf16 v[108:111], v[168:171], v[200:203], v[108:111]
    ds_read_b64_tr_b16 v[168:169], v242 offset:9792
    ds_read_b64_tr_b16 v[170:171], v242 offset:10944
    v_mfma_f32_16x16x32_bf16 v[112:115], v[172:175], v[188:191], v[112:115]
    v_mfma_f32_16x16x32_bf16 v[116:119], v[172:175], v[192:195], v[116:119]
    v_mfma_f32_16x16x32_bf16 v[120:123], v[172:175], v[196:199], v[120:123]
    v_mfma_f32_16x16x32_bf16 v[124:127], v[172:175], v[200:203], v[124:127]
    v_mfma_f32_16x16x32_bf16 v[128:131], v[176:179], v[188:191], v[128:131]
    v_mfma_f32_16x16x32_bf16 v[132:135], v[176:179], v[192:195], v[132:135]
    v_mfma_f32_16x16x32_bf16 v[136:139], v[176:179], v[196:199], v[136:139]
    v_mfma_f32_16x16x32_bf16 v[140:143], v[176:179], v[200:203], v[140:143]
k3_skip_32:
    s_waitcnt vmcnt(14) lgkmcnt(0)
    s_barrier
    s_add_u32 m0, s50, 0x2580
    s_nop 0
    buffer_load_dwordx4 v236, s[20:23], s33 offen lds
    s_add_u32 m0, s51, 0x2580
    s_nop 0
    buffer_load_dwordx4 v237, s[20:23], s33 offen lds
    s_add_u32 m0, s52, 0x2580
    s_nop 0
    buffer_load_dwordx4 v238, s[20:23], s33 offen lds
    s_add_u32 m0, s53, 0x2580
    s_nop 0
    buffer_load_dwordx4 v239, s[20:23], s33 offen lds
    s_add_u32 m0, s54, 0x2580
    s_mov_b32 exec_hi, 0xfff
    buffer_load_dwordx4 v240, s[20:23], s33 offen lds
    s_mov_b64 exec, -1
    s_add_u32 s33, s33, 0x9000
    buffer_load_dwordx4 v[188:191], v241, s[16:19], s36 offen
    s_add_u32 s36, s36, 0x400
    buffer_load_dwordx4 v[192:195], v241, s[16:19], s37 offen
    s_add_u32 s37, s37, 0x400
    buffer_load_dwordx4 v[196:199], v241, s[16:19], s38 offen
    s_add_u32 s38, s38, 0x400
    buffer_load_dwordx4 v[200:203], v241, s[16:19], s39 offen
    s_add_u32 s39, s39, 0x400
    ds_read_b64_tr_b16 v[172:173], v242 offset:19424
    ds_read_b64_tr_b16 v[174:175], v242 offset:20576
    ds_read_b64_tr_b16 v[176:177], v242 offset:19456
    ds_read_b64_tr_b16 v[178:179], v242 offset:20608
    v_mfma_f32_16x16x32_bf16 v[0:3], v[144:147], v[204:207], v[0:3]
    v_mfma_f32_16x16x32_bf16 v[4:7], v[144:147], v[208:211], v[4:7]
    v_mfma_f32_16x16x32_bf16 v[8:11], v[144:147], v[212:215], v[8:11]
    v_mfma_f32_16x16x32_bf16 v[12:15], v[144:147], v[216:219], v[12:15]
    ds_read_b64_tr_b16 v[144:145], v242 offset:19200
    ds_read_b64_tr_b16 v[146:147], v242 offset:20352
    v_mfma_f32_16x16x32_bf16 v[16:19], v[148:151], v[204:207], v[16:19]
    v_mfma_f32_16x16x32_bf16 v[20:23], v[148:151], v[208:211], v[20:23]
    v_mfma_f32_16x16x32_bf16 v[24:27], v[148:151], v[212:215], v[24:27]
    v_mfma_f32_16x16x32_bf16 v[28:31], v[148:151], v[216:219], v[28:31]
    ds_read_b64_tr_b16 v[148:149], v242 offset:19232
    ds_read_b64_tr_b16 v[150:151], v242 offset:20384
    v_mfma_f32_16x16x32_bf16 v[32:35], v[152:155], v[204:207], v[32:35]
    v_mfma_f32_16x16x32_bf16 v[36:39], v[152:155], v[208:211], v[36:39]
    v_mfma_f32_16x16x32_bf16 v[40:43], v[152:155], v[212:215], v[40:43]
    v_mfma_f32_16x16x32_bf16 v[44:47], v[152:155], v[216:219], v[44:47]
    ds_read_b64_tr_b16 v[152:153], v242 offset:19264
    ds_read_b64_tr_b16 v[154:155], v242 offset:20416
    v_mfma_f32_16x16x32_bf16 v[48:51], v[156:159], v[204:207], v[48:51]
    v_mfma_f32_16x16x32_bf16 v[52:55], v[156:159], v[208:211], v[52:55]
    v_mfma_f32_16x16x32_bf16 v[56:59], v[156:159], v[212:215], v[56:59]
    v_mfma_f32_16x16x32_bf16 v[60:63], v[156:159], v[216:219], v[60:63]
    ds_read_b64_tr_b16 v[156:157], v242 offset:19296
    ds_read_b64_tr_b16 v[158:159], v242 offset:20448
    v_mfma_f32_16x16x32_bf16 v[64:67], v[160:163], v[204:207], v[64:67]
    v_mfma_f32_16x16x32_bf16 v[68:71], v[160:163], v[208:211], v[68:71]
    v_mfma_f32_16x16x32_bf16 v[72:75], v[160:163], v[212:215], v[72:75]
    v_mfma_f32_16x16x32_bf16 v[76:79], v[160:163], v[216:219], v[76:79]
    ds_read_b64_tr_b16 v[160:161], v242 offset:19328
    ds_read_b64_tr_b16 v[162:163], v242 offset:20480
    v_mfma_f32_16x16x32_bf16 v[80:83], v[164:167], v[204:207], v[80:83]
    v_mfma_f32_16x16x32_bf16 v[84:87], v[164:167], v[208:211], v[84:87]
    v_mfma_f32_16x16x32_bf16 v[88:91], v[164:167], v[212:215], v[88:91]
    v_mfma_f32_16x16x32_bf16 v[92:95], v[164:167], v[216:219], v[92:95]
    ds_read_b64_tr_b16 v[164:165], v242 offset:19360
    ds_read_b64_tr_b16 v[166:167], v242 offset:20512
    v_mfma_f32_16x16x32_bf16 v[96:99], v[168:171], v[204:207], v[96:99]
    v_mfma_f32_16x16x32_bf16 v[100:103], v[168:171], v[208:211], v[100:103]
    v_mfma_f32_16x16x32_bf16 v[104:107], v[168:171], v[212:215], v[104:107]
    v_mfma_f32_16x16x32_bf16 v[108:111], v[168:171], v[216:219], v[108:111]
    ds_read_b64_tr_b16 v[168:169], v242 offset:19392
    ds_read_b64_tr_b16 v[170:171], v242 offset:20544
    v_mfma_f32_16x16x32_bf16 v[112:115], v[180:183], v[204:207], v[112:115]
    v_mfma_f32_16x16x32_bf16 v[116:119], v[180:183], v[208:211], v[116:119]
    v_mfma_f32_16x16x32_bf16 v[120:123], v[180:183], v[212:215], v[120:123]
    v_mfma_f32_16x16x32_bf16 v[124:127], v[180:183], v[216:219], v[124:127]
    v_mfma_f32_16x16x32_bf16 v[128:131], v[184:187], v[204:207], v[128:131]
    v_mfma_f32_16x16x32_bf16 v[132:135], v[184:187], v[208:211], v[132:135]
    v_mfma_f32_16x16x32_bf16 v[136:139], v[184:187], v[212:215], v[136:139]
    v_mfma_f32_16x16x32_bf16 v[140:143], v[184:187], v[216:219], v[140:143]
k3_skip_33:
    s_waitcnt vmcnt(9) lgkmcnt(0)
    s_barrier
    s_add_u32 m0, s50, 0x4b00
    s_nop 0
    buffer_load_dwordx4 v236, s[20:23], s33 offen lds
    s_add_u32 m0, s51, 0x4b00
    s_nop 0
    buffer_load_dwordx4 v237, s[20:23], s33 offen lds
    s_add_u32 m0, s52, 0x4b00
    s_nop 0
    buffer_load_dwordx4 v238, s[20:23], s33 offen lds
    s_add_u32 m0, s53, 0x4b00
    s_nop 0
    buffer_load_dwordx4 v239, s[20:23], s33 offen lds
    s_add_u32 m0, s54, 0x4b00
    s_mov_b32 exec_hi, 0xfff
    buffer_load_dwordx4 v240, s[20:23], s33 offen lds
    s_mov_b64 exec, -1
    s_add_u32 s33, s33, 0x9000
    buffer_load_dwordx4 v[204:207], v241, s[16:19], s36 offen
    s_add_u32 s36, s36, 0x400
    buffer_load_dwordx4 v[208:211], v241, s[16:19], s37 offen
    s_add_u32 s37, s37, 0x400
    buffer_load_dwordx4 v[212:215], v241, s[16:19], s38 offen
    s_add_u32 s38, s38, 0x400
    buffer_load_dwordx4 v[216:219], v241, s[16:19], s39 offen
    s_add_u32 s39, s39, 0x400
    ds_read_b64_tr_b16 v[180:181], v242 offset:29024
    ds_read_b64_tr_b16 v[182:183], v242 offset:30176
    ds_read_b64_tr_b16 v[184:185], v242 offset:29056
    ds_read_b64_tr_b16 v[186:187], v242 offset:30208
    v_mfma_f32_16x16x32_bf16 v[0:3], v[144:147], v[220:223], v[0:3]
    v_mfma_f32_16x16x32_bf16 v[4:7], v[144:147], v[224:227], v[4:7]
    v_mfma_f32_16x16x32_bf16 v[8:11], v[144:147], v[228:231], v[8:11]
    v_mfma_f32_16x16x32_bf16 v[12:15], v[144:147], v[232:235], v[12:15]
    ds_read_b64_tr_b16 v[144:145], v242 offset:28800
    ds_read_b64_tr_b16 v[146:147], v242 offset:29952
    v_mfma_f32_16x16x32_bf16 v[16:19], v[148:151], v[220:223], v[16:19]
    v_mfma_f32_16x16x32_bf16 v[20:23], v[148:151], v[224:227], v[20:23]
    v_mfma_f32_16x16x32_bf16 v[24:27], v[148:151], v[228:231], v[24:27]
    v_mfma_f32_16x16x32_bf16 v[28:31], v[148:151], v[232:235], v[28:31]
    ds_read_b64_tr_b16 v[148:149], v242 offset:28832
    ds_read_b64_tr_b16 v[150:151], v242 offset:29984
    v_mfma_f32_16x16x32_bf16 v[32:35], v[152:155], v[220:223], v[32:35]
    v_mfma_f32_16x16x32_bf16 v[36:39], v[152:155], v[224:227], v[36:39]
    v_mfma_f32_16x16x32_bf16 v[40:43], v[152:155], v[228:231], v[40:43]
    v_mfma_f32_16x16x32_bf16 v[44:47], v[152:155], v[232:235], v[44:47]
    ds_read_b64_tr_b16 v[152:153], v242 offset:28864
    ds_read_b64_tr_b16 v[154:155], v242 offset:30016
    v_mfma_f32_16x16x32_bf16 v[48:51], v[156:159], v[220:223], v[48:51]
    v_mfma_f32_16x16x32_bf16 v[52:55], v[156:159], v[224:227], v[52:55]
    v_mfma_f32_16x16x32_bf16 v[56:59], v[156:159], v[228:231], v[56:59]
    v_mfma_f32_16x16x32_bf16 v[60:63], v[156:159], v[232:235], v[60:63]
    ds_read_b64_tr_b16 v[156:157], v242 offset:28896
    ds_read_b64_tr_b16 v[158:159], v242 offset:30048
    v_mfma_f32_16x16x32_bf16 v[64:67], v[160:163], v[220:223], v[64:67]
    v_mfma_f32_16x16x32_bf16 v[68:71], v[160:163], v[224:227], v[68:71]
    v_mfma_f32_16x16x32_bf16 v[72:75], v[160:163], v[228:231], v[72:75]
    v_mfma_f32_16x16x32_bf16 v[76:79], v[160:163], v[232:235], v[76:79]
    ds_read_b64_tr_b16 v[160:161], v242 offset:28928
    ds_read_b64_tr_b16 v[162:163], v242 offset:30080
    v_mfma_f32_16x16x32_bf16 v[80:83], v[164:167], v[220:223], v[80:83]
    v_mfma_f32_16x16x32_bf16 v[84:87], v[164:167], v[224:227], v[84:87]
    v_mfma_f32_16x16x32_bf16 v[88:91], v[164:167], v[228:231], v[88:91]
    v_mfma_f32_16x16x32_bf16 v[92:95], v[164:167], v[232:235], v[92:95]
    ds_read_b64_tr_b16 v[164:165], v242 offset:28960
    ds_read_b64_tr_b16 v[166:167], v242 offset:30112
    v_mfma_f32_16x16x32_bf16 v[96:99], v[168:171], v[220:223], v[96:99]
    v_mfma_f32_16x16x32_bf16 v[100:103], v[168:171], v[224:227], v[100:103]
    v_mfma_f32_16x16x32_bf16 v[104:107], v[168:171], v[228:231], v[104:107]
    v_mfma_f32_16x16x32_bf16 v[108:111], v[168:171], v[232:235], v[108:111]
    ds_read_b64_tr_b16 v[168:169], v242 offset:28992
    ds_read_b64_tr_b16 v[170:171], v242 offset:30144
    v_mfma_f32_16x16x32_bf16 v[112:115], v[172:175], v[220:223], v[112:115]
    v_mfma_f32_16x16x32_bf16 v[116:119], v[172:175], v[224:227], v[116:119]
    v_mfma_f32_16x16x32_bf16 v[120:123], v[172:175], v[228:231], v[120:123]
    v_mfma_f32_16x16x32_bf16 v[124:127], v[172:175], v[232:235], v[124:127]
    v_mfma_f32_16x16x32_bf16 v[128:131], v[176:179], v[220:223], v[128:131]
    v_mfma_f32_16x16x32_bf16 v[132:135], v[176:179], v[224:227], v[132:135]
    v_mfma_f32_16x16x32_bf16 v[136:139], v[176:179], v[228:231], v[136:139]
    v_mfma_f32_16x16x32_bf16 v[140:143], v[176:179], v[232:235], v[140:143]
k3_skip_34:
    s_waitcnt vmcnt(9) lgkmcnt(0)
    s_barrier
    s_add_u32 m0, s50, 0x7080
    s_nop 0
    buffer_load_dwordx4 v236, s[20:23], s33 offen lds
    s_add_u32 m0, s51, 0x7080
    s_nop 0
    buffer_load_dwordx4 v237, s[20:23], s33 offen lds
    s_add_u32 m0, s52, 0x7080
    s_nop 0
    buffer_load_dwordx4 v238, s[20:23], s33 offen lds
    s_add_u32 m0, s53, 0x7080
    s_nop 0
    buffer_load_dwordx4 v239, s[20:23], s33 offen lds
    s_add_u32 m0, s54, 0x7080
    s_mov_b32 exec_hi, 0xfff
    buffer_load_dwordx4 v240, s[20:23], s33 offen lds
    s_mov_b64 exec, -1
    s_add_u32 s33, s33, 0x9000
    buffer_load_dwordx4 v[220:223], v241, s[16:19], s36 offen
    s_add_u32 s36, s36, 0x400
    buffer_load_dwordx4 v[224:227], v241, s[16:19], s37 offen
    s_add_u32 s37, s37, 0x400
    buffer_load_dwordx4 v[228:231], v241, s[16:19], s38 offen
    s_add_u32 s38, s38, 0x400
    buffer_load_dwordx4 v[232:235], v241, s[16:19], s39 offen
    s_add_u32 s39, s39, 0x400
    ds_read_b64_tr_b16 v[172:173], v242 offset:224
    ds_read_b64_tr_b16 v[174:175], v242 offset:1376
    ds_read_b64_tr_b16 v[176:177], v242 offset:256
    ds_read_b64_tr_b16 v[178:179], v242 offset:1408
    v_mfma_f32_16x16x32_bf16 v[0:3], v[144:147], v[188:191], v[0:3]
    v_mfma_f32_16x16x32_bf16 v[4:7], v[144:147], v[192:195], v[4:7]
    v_mfma_f32_16x16x32_bf16 v[8:11], v[144:147], v[196:199], v[8:11]
    v_mfma_f32_16x16x32_bf16 v[12:15], v[144:147], v[200:203], v[12:15]
    ds_read_b64_tr_b16 v[144:145], v242 offset:0
    ds_read_b64_tr_b16 v[146:147], v242 offset:1152
    v_mfma_f32_16x16x32_bf16 v[16:19], v[148:151], v[188:191], v[16:19]
    v_mfma_f32_16x16x32_bf16 v[20:23], v[148:151], v[192:195], v[20:23]
    v_mfma_f32_16x16x32_bf16 v[24:27], v[148:151], v[196:199], v[24:27]
    v_mfma_f32_16x16x32_bf16 v[28:31], v[148:151], v[200:203], v[28:31]
    ds_read_b64_tr_b16 v[148:149], v242 offset:32
    ds_read_b64_tr_b16 v[150:151], v242 offset:1184
    v_mfma_f32_16x16x32_bf16 v[32:35], v[152:155], v[188:191], v[32:35]
    v_mfma_f32_16x16x32_bf16 v[36:39], v[152:155], v[192:195], v[36:39]
    v_mfma_f32_16x16x32_bf16 v[40:43], v[152:155], v[196:199], v[40:43]
    v_mfma_f32_16x16x32_bf16 v[44:47], v[152:155], v[200:203], v[44:47]
    ds_read_b64_tr_b16 v[152:153], v242 offset:64
    ds_read_b64_tr_b16 v[154:155], v242 offset:1216
    v_mfma_f32_16x16x32_bf16 v[48:51], v[156:159], v[188:191], v[48:51]
    v_mfma_f32_16x16x32_bf16 v[52:55], v[156:159], v[192:195], v[52:55]
    v_mfma_f32_16x16x32_bf16 v[56:59], v[156:159], v[196:199], v[56:59]
    v_mfma_f32_16x16x32_bf16 v[60:63], v[156:159], v[200:203], v[60:63]
    ds_read_b64_tr_b16 v[156:157], v242 offset:96
    ds_read_b64_tr_b16 v[158:159], v242 offset:1248
    v_mfma_f32_16x16x32_bf16 v[64:67], v[160:163], v[188:191], v[64:67]
    v_mfma_f32_16x16x32_bf16 v[68:71], v[160:163], v[192:195], v[68:71]
    v_mfma_f32_16x16x32_bf16 v[72:75], v[160:163], v[196:199], v[72:75]
    v_mfma_f32_16x16x32_bf16 v[76:79], v[160:163], v[200:203], v[76:79]
    ds_read_b64_tr_b16 v[160:161], v242 offset:128
    ds_read_b64_tr_b16 v[162:163], v242 offset:1280
    v_mfma_f32_16x16x32_bf16 v[80:83], v[164:167], v[188:191], v[80:83]
    v_mfma_f32_16x16x32_bf16 v[84:87], v[164:167], v[192:195], v[84:87]
    v_mfma_f32_16x16x32_bf16 v[88:91], v[164:167], v[196:199], v[88:91]
    v_mfma_f32_16x16x32_bf16 v[92:95], v[164:167], v[200:203], v[92:95]
    ds_read_b64_tr_b16 v[164:165], v242 offset:160
    ds_read_b64_tr_b16 v[166:167], v242 offset:1312
    v_mfma_f32_16x16x32_bf16 v[96:99], v[168:171], v[188:191], v[96:99]
    v_mfma_f32_16x16x32_bf16 v[100:103], v[168:171], v[192:195], v[100:103]
    v_mfma_f32_16x16x32_bf16 v[104:107], v[168:171], v[196:199], v[104:107]
    v_mfma_f32_16x16x32_bf16 v[108:111], v[168:171], v[200:203], v[108:111]
    ds_read_b64_tr_b16 v[168:169], v242 offset:192
    ds_read_b64_tr_b16 v[170:171], v242 offset:1344
    v_mfma_f32_16x16x32_bf16 v[112:115], v[180:183], v[188:191], v[112:115]
    v_mfma_f32_16x16x32_bf16 v[116:119], v[180:183], v[192:195], v[116:119]
    v_mfma_f32_16x16x32_bf16 v[120:123], v[180:183], v[196:199], v[120:123]
    v_mfma_f32_16x16x32_bf16 v[124:127], v[180:183], v[200:203], v[124:127]
    v_mfma_f32_16x16x32_bf16 v[128:131], v[184:187], v[188:191], v[128:131]
    v_mfma_f32_16x16x32_bf16 v[132:135], v[184:187], v[192:195], v[132:135]
    v_mfma_f32_16x16x32_bf16 v[136:139], v[184:187], v[196:199], v[136:139]
    v_mfma_f32_16x16x32_bf16 v[140:143], v[184:187], v[200:203], v[140:143]
k3_skip_35:
    s_waitcnt vmcnt(9) lgkmcnt(0)
    s_barrier
    s_add_u32 m0, s50, 0
    s_nop 0
    buffer_load_dwordx4 v236, s[20:23], s33 offen lds
    s_add_u32 m0, s51, 0
    s_nop 0
    buffer_load_dwordx4 v237, s[20:23], s33 offen lds
    s_add_u32 m0, s52, 0
    s_nop 0
    buffer_load_dwordx4 v238, s[20:23], s33 offen lds
    s_add_u32 m0, s53, 0
    s_nop 0
    buffer_load_dwordx4 v239, s[20:23], s33 offen lds
    s_add_u32 m0, s54, 0
    s_mov_b32 exec_hi, 0xfff
    buffer_load_dwordx4 v240, s[20:23], s33 offen lds
    s_mov_b64 exec, -1
    s_add_u32 s33, s33, 0x9000
    buffer_load_dwordx4 v[188:191], v241, s[16:19], s36 offen
    s_add_u32 s36, s36, 0x400
    buffer_load_dwordx4 v[192:195], v241, s[16:19], s37 offen
    s_add_u32 s37, s37, 0x400
    buffer_load_dwordx4 v[196:199], v241, s[16:19], s38 offen
    s_add_u32 s38, s38, 0x400
    buffer_load_dwordx4 v[200:203], v241, s[16:19], s39 offen
    s_add_u32 s39, s39, 0x400
    ds_read_b64_tr_b16 v[180:181], v242 offset:9824
    ds_read_b64_tr_b16 v[182:183], v242 offset:10976
    ds_read_b64_tr_b16 v[184:185], v242 offset:9856
    ds_read_b64_tr_b16 v[186:187], v242 offset:11008
    v_mfma_f32_16x16x32_bf16 v[0:3], v[144:147], v[204:207], v[0:3]
    v_mfma_f32_16x16x32_bf16 v[4:7], v[144:147], v[208:211], v[4:7]
    v_mfma_f32_16x16x32_bf16 v[8:11], v[144:147], v[212:215], v[8:11]
    v_mfma_f32_16x16x32_bf16 v[12:15], v[144:147], v[216:219], v[12:15]
    ds_read_b64_tr_b16 v[144:145], v242 offset:9600
    ds_read_b64_tr_b16 v[146:147], v242 offset:10752
    v_mfma_f32_16x16x32_bf16 v[16:19], v[148:151], v[204:207], v[16:19]
    v_mfma_f32_16x16x32_bf16 v[20:23], v[148:151], v[208:211], v[20:23]
    v_mfma_f32_16x16x32_bf16 v[24:27], v[148:151], v[212:215], v[24:27]
    v_mfma_f32_16x16x32_bf16 v[28:31], v[148:151], v[216:219], v[28:31]
    ds_read_b64_tr_b16 v[148:149], v242 offset:9632
    ds_read_b64_tr_b16 v[150:151], v242 offset:10784
    v_mfma_f32_16x16x32_bf16 v[32:35], v[152:155], v[204:207], v[32:35]
    v_mfma_f32_16x16x32_bf16 v[36:39], v[152:155], v[208:211], v[36:39]
    v_mfma_f32_16x16x32_bf16 v[40:43], v[152:155], v[212:215], v[40:43]
    v_mfma_f32_16x16x32_bf16 v[44:47], v[152:155], v[216:219], v[44:47]
    ds_read_b64_tr_b16 v[152:153], v242 offset:9664
    ds_read_b64_tr_b16 v[154:155], v242 offset:10816
    v_mfma_f32_16x16x32_bf16 v[48:51], v[156:159], v[204:207], v[48:51]
    v_mfma_f32_16x16x32_bf16 v[52:55], v[156:159], v[208:211], v[52:55]
    v_mfma_f32_16x16x32_bf16 v[56:59], v[156:159], v[212:215], v[56:59]
    v_mfma_f32_16x16x32_bf16 v[60:63], v[156:159], v[216:219], v[60:63]
    ds_read_b64_tr_b16 v[156:157], v242 offset:9696
    ds_read_b64_tr_b16 v[158:159], v242 offset:10848
    v_mfma_f32_16x16x32_bf16 v[64:67], v[160:163], v[204:207], v[64:67]
    v_mfma_f32_16x16x32_bf16 v[68:71], v[160:163], v[208:211], v[68:71]
    v_mfma_f32_16x16x32_bf16 v[72:75], v[160:163], v[212:215], v[72:75]
    v_mfma_f32_16x16x32_bf16 v[76:79], v[160:163], v[216:219], v[76:79]
    ds_read_b64_tr_b16 v[160:161], v242 offset:9728
    ds_read_b64_tr_b16 v[162:163], v242 offset:10880
    v_mfma_f32_16x16x32_bf16 v[80:83], v[164:167], v[204:207], v[80:83]
    v_mfma_f32_16x16x32_bf16 v[84:87], v[164:167], v[208:211], v[84:87]
    v_mfma_f32_16x16x32_bf16 v[88:91], v[164:167], v[212:215], v[88:91]
    v_mfma_f32_16x16x32_bf16 v[92:95], v[164:167], v[216:219], v[92:95]
    ds_read_b64_tr_b16 v[164:165], v242 offset:9760
    ds_read_b64_tr_b16 v[166:167], v242 offset:10912
    v_mfma_f32_16x16x32_bf16 v[96:99], v[168:171], v[204:207], v[96:99]
    v_mfma_f32_16x16x32_bf16 v[100:103], v[168:171], v[208:211], v[100:103]
    v_mfma_f32_16x16x32_bf16 v[104:107], v[168:171], v[212:215], v[104:107]
    v_mfma_f32_16x16x32_bf16 v[108:111], v[168:171], v[216:219], v[108:111]
    ds_read_b64_tr_b16 v[168:169], v242 offset:9792
    ds_read_b64_tr_b16 v[170:171], v242 offset:10944
    v_mfma_f32_16x16x32_bf16 v[112:115], v[172:175], v[204:207], v[112:115]
    v_mfma_f32_16x16x32_bf16 v[116:119], v[172:175], v[208:211], v[116:119]
    v_mfma_f32_16x16x32_bf16 v[120:123], v[172:175], v[212:215], v[120:123]
    v_mfma_f32_16x16x32_bf16 v[124:127], v[172:175], v[216:219], v[124:127]
    v_mfma_f32_16x16x32_bf16 v[128:131], v[176:179], v[204:207], v[128:131]
    v_mfma_f32_16x16x32_bf16 v[132:135], v[176:179], v[208:211], v[132:135]
    v_mfma_f32_16x16x32_bf16 v[136:139], v[176:179], v[212:215], v[136:139]
    v_mfma_f32_16x16x32_bf16 v[140:143], v[176:179], v[216:219], v[140:143]
k3_skip_36:
    s_waitcnt vmcnt(9) lgkmcnt(0)
    s_barrier
    s_cmp_lt_u32 9, s34
    s_cbranch_scc0 k3n_38
    s_add_u32 m0, s50, 0x2580
    s_nop 0
    buffer_load_dwordx4 v236, s[64:67], s68 offen lds
    s_add_u32 m0, s51, 0x2580
    s_nop 0
    buffer_load_dwordx4 v237, s[64:67], s68 offen lds
    s_add_u32 m0, s52, 0x2580
    s_nop 0
    buffer_load_dwordx4 v238, s[64:67], s68 offen lds
    s_add_u32 m0, s53, 0x2580
    s_nop 0
    buffer_load_dwordx4 v239, s[64:67], s68 offen lds
    s_add_u32 m0, s54, 0x2580
    s_mov_b32 exec_hi, 0xfff
    buffer_load_dwordx4 v240, s[64:67], s68 offen lds
    s_mov_b64 exec, -1
    s_add_u32 s68, s68, 0x9000
k3n_38:
    buffer_load_dwordx4 v[204:207], v241, s[16:19], s36 offen
    s_add_u32 s36, s36, 0x400
    buffer_load_dwordx4 v[208:211], v241, s[16:19], s37 offen
    s_add_u32 s37, s37, 0x400
    buffer_load_dwordx4 v[212:215], v241, s[16:19], s38 offen
    s_add_u32 s38, s38, 0x400
    buffer_load_dwordx4 v[216:219], v241, s[16:19], s39 offen
    s_add_u32 s39, s39, 0x400
    ds_read_b64_tr_b16 v[172:173], v242 offset:19424
    ds_read_b64_tr_b16 v[174:175], v242 offset:20576
    ds_read_b64_tr_b16 v[176:177], v242 offset:19456
    ds_read_b64_tr_b16 v[178:179], v242 offset:20608
    v_mfma_f32_16x16x32_bf16 v[0:3], v[144:147], v[220:223], v[0:3]
    v_mfma_f32_16x16x32_bf16 v[4:7], v[144:147], v[224:227], v[4:7]
    v_mfma_f32_16x16x32_bf16 v[8:11], v[144:147], v[228:231], v[8:11]
    v_mfma_f32_16x16x32_bf16 v[12:15], v[144:147], v[232:235], v[12:15]
    ds_read_b64_tr_b16 v[144:145], v242 offset:19200
    ds_read_b64_tr_b16 v[146:147], v242 offset:20352
    v_mfma_f32_16x16x32_bf16 v[16:19], v[148:151], v[220:223], v[16:19]
    v_mfma_f32_16x16x32_bf16 v[20:23], v[148:151], v[224:227], v[20:23]
    v_mfma_f32_16x16x32_bf16 v[24:27], v[148:151], v[228:231], v[24:27]
    v_mfma_f32_16x16x32_bf16 v[28:31], v[148:151], v[232:235], v[28:31]
    ds_read_b64_tr_b16 v[148:149], v242 offset:19232
    ds_read_b64_tr_b16 v[150:151], v242 offset:20384
    v_mfma_f32_16x16x32_bf16 v[32:35], v[152:155], v[220:223], v[32:35]
    v_mfma_f32_16x16x32_bf16 v[36:39], v[152:155], v[224:227], v[36:39]
    v_mfma_f32_16x16x32_bf16 v[40:43], v[152:155], v[228:231], v[40:43]
    v_mfma_f32_16x16x32_bf16 v[44:47], v[152:155], v[232:235], v[44:47]
    ds_read_b64_tr_b16 v[152:153], v242 offset:19264
    ds_read_b64_tr_b16 v[154:155], v242 offset:20416
    v_mfma_f32_16x16x32_bf16 v[48:51], v[156:159], v[220:223], v[48:51]
    v_mfma_f32_16x16x32_bf16 v[52:55], v[156:159], v[224:227], v[52:55]
    v_mfma_f32_16x16x32_bf16 v[56:59], v[156:159], v[228:231], v[56:59]
    v_mfma_f32_16x16x32_bf16 v[60:63], v[156:159], v[232:235], v[60:63]
    ds_read_b64_tr_b16 v[156:157], v242 offset:19296
    ds_read_b64_tr_b16 v[158:159], v242 offset:20448
    v_mfma_f32_16x16x32_bf16 v[64:67], v[160:163], v[220:223], v[64:67]
    v_mfma_f32_16x16x32_bf16 v[68:71], v[160:163], v[224:227], v[68:71]
    v_mfma_f32_16x16x32_bf16 v[72:75], v[160:163], v[228:231], v[72:75]
    v_mfma_f32_16x16x32_bf16 v[76:79], v[160:163], v[232:235], v[76:79]
    ds_read_b64_tr_b16 v[160:161], v242 offset:19328
    ds_read_b64_tr_b16 v[162:163], v242 offset:20480
    v_mfma_f32_16x16x32_bf16 v[80:83], v[164:167], v[220:223], v[80:83]
    v_mfma_f32_16x16x32_bf16 v[84:87], v[164:167], v[224:227], v[84:87]
    v_mfma_f32_16x16x32_bf16 v[88:91], v[164:167], v[228:231], v[88:91]
    v_mfma_f32_16x16x32_bf16 v[92:95], v[164:167], v[232:235], v[92:95]
    ds_read_b64_tr_b16 v[164:165], v242 offset:19360
    ds_read_b64_tr_b16 v[166:167], v242 offset:20512
    v_mfma_f32_16x16x32_bf16 v[96:99], v[168:171], v[220:223], v[96:99]
    v_mfma_f32_16x16x32_bf16 v[100:103], v[168:171], v[224:227], v[100:103]
    v_mfma_f32_16x16x32_bf16 v[104:107], v[168:171], v[228:231], v[104:107]
    v_mfma_f32_16x16x32_bf16 v[108:111], v[168:171], v[232:235], v[108:111]
    ds_read_b64_tr_b16 v[168:169], v242 offset:19392
    ds_read_b64_tr_b16 v[170:171], v242 offset:20544
    v_mfma_f32_16x16x32_bf16 v[112:115], v[180:183], v[220:223], v[112:115]
    v_mfma_f32_16x16x32_bf16 v[116:119], v[180:183], v[224:227], v[116:119]
    v_mfma_f32_16x16x32_bf16 v[120:123], v[180:183], v[228:231], v[120:123]
    v_mfma_f32_16x16x32_bf16 v[124:127], v[180:183], v[232:235], v[124:127]
    v_mfma_f32_16x16x32_bf16 v[128:131], v[184:187], v[220:223], v[128:131]
    v_mfma_f32_16x16x32_bf16 v[132:135], v[184:187], v[224:227], v[132:135]
    v_mfma_f32_16x16x32_bf16 v[136:139], v[184:187], v[228:231], v[136:139]
    v_mfma_f32_16x16x32_bf16 v[140:143], v[184:187], v[232:235], v[140:143]
k3_skip_37:
    s_cmp_lt_u32 9, s34
    s_cbranch_scc1 k3w_40
    s_cmp_lt_u32 7, s34
    s_cbranch_scc1 k3w_41
    s_waitcnt vmcnt(0) lgkmcnt(0)
    s_branch k3w_42
k3w_40:
    s_waitcnt vmcnt(9) lgkmcnt(0)
    s_branch k3w_42
k3w_41:
    s_waitcnt vmcnt(4) lgkmcnt(0)
k3w_42:
    s_barrier
    s_cmp_lt_u32 10, s34
    s_cbranch_scc0 k3n_43
    s_add_u32 m0, s50, 0x4b00
    s_nop 0
    buffer_load_dwordx4 v236, s[64:67], s68 offen lds
    s_add_u32 m0, s51, 0x4b00
    s_nop 0
    buffer_load_dwordx4 v237, s[64:67], s68 offen lds
    s_add_u32 m0, s52, 0x4b00
    s_nop 0
    buffer_load_dwordx4 v238, s[64:67], s68 offen lds
    s_add_u32 m0, s53, 0x4b00
    s_nop 0
    buffer_load_dwordx4 v239, s[64:67], s68 offen lds
    s_add_u32 m0, s54, 0x4b00
    s_mov_b32 exec_hi, 0xfff
    buffer_load_dwordx4 v240, s[64:67], s68 offen lds
    s_mov_b64 exec, -1
    s_add_u32 s68, s68, 0x9000
k3n_43:
    buffer_load_dwordx4 v[220:223], v241, s[16:19], s36 offen
    s_add_u32 s36, s36, 0x400
    buffer_load_dwordx4 v[224:227], v241, s[16:19], s37 offen
    s_add_u32 s37, s37, 0x400
    buffer_load_dwordx4 v[228:231], v241, s[16:19], s38 offen
    s_add_u32 s38, s38, 0x400
    buffer_load_dwordx4 v[232:235], v241, s[16:19], s39 offen
    s_add_u32 s39, s39, 0x400
    ds_read_b64_tr_b16 v[180:181], v242 offset:29024
    ds_read_b64_tr_b16 v[182:183], v242 offset:30176
    ds_read_b64_tr_b16 v[184:185], v242 offset:29056
    ds_read_b64_tr_b16 v[186:187], v242 offset:30208
    v_mfma_f32_16x16x32_bf16 v[0:3], v[144:147], v[188:191], v[0:3]
    v_mfma_f32_16x16x32_bf16 v[4:7], v[144:147], v[192:195], v[4:7]
    v_mfma_f32_16x16x32_bf16 v[8:11], v[144:147], v[196:199], v[8:11]
    v_mfma_f32_16x16x32_bf16 v[12:15], v[144:147], v[200:203], v[12:15]
    ds_read_b64_tr_b16 v[144:145], v242 offset:28800
    ds_read_b64_tr_b16 v[146:147], v242 offset:29952
    v_mfma_f32_16x16x32_bf16 v[16:19], v[148:151], v[188:191], v[16:19]
    v_mfma_f32_16x16x32_bf16 v[20:23], v[148:151], v[192:195], v[20:23]
    v_mfma_f32_16x16x32_bf16 v[24:27], v[148:151], v[196:199], v[24:27]
    v_mfma_f32_16x16x32_bf16 v[28:31], v[148:151], v[200:203], v[28:31]
    ds_read_b64_tr_b16 v[148:149], v242 offset:28832
    ds_read_b64_tr_b16 v[150:151], v242 offset:29984
    v_mfma_f32_16x16x32_bf16 v[32:35], v[152:155], v[188:191], v[32:35]
    v_mfma_f32_16x16x32_bf16 v[36:39], v[152:155], v[192:195], v[36:39]
    v_mfma_f32_16x16x32_bf16 v[40:43], v[152:155], v[196:199], v[40:43]
    v_mfma_f32_16x16x32_bf16 v[44:47], v[152:155], v[200:203], v[44:47]
    ds_read_b64_tr_b16 v[152:153], v242 offset:28864
    ds_read_b64_tr_b16 v[154:155], v242 offset:30016
    v_mfma_f32_16x16x32_bf16 v[48:51], v[156:159], v[188:191], v[48:51]
    v_mfma_f32_16x16x32_bf16 v[52:55], v[156:159], v[192:195], v[52:55]
    v_mfma_f32_16x16x32_bf16 v[56:59], v[156:159], v[196:199], v[56:59]
    v_mfma_f32_16x16x32_bf16 v[60:63], v[156:159], v[200:203], v[60:63]
    ds_read_b64_tr_b16 v[156:157], v242 offset:28896
    ds_read_b64_tr_b16 v[158:159], v242 offset:30048
    v_mfma_f32_16x16x32_bf16 v[64:67], v[160:163], v[188:191], v[64:67]
    v_mfma_f32_16x16x32_bf16 v[68:71], v[160:163], v[192:195], v[68:71]
    v_mfma_f32_16x16x32_bf16 v[72:75], v[160:163], v[196:199], v[72:75]
    v_mfma_f32_16x16x32_bf16 v[76:79], v[160:163], v[200:203], v[76:79]
    ds_read_b64_tr_b16 v[160:161], v242 offset:28928
    ds_read_b64_tr_b16 v[162:163], v242 offset:30080
    v_mfma_f32_16x16x32_bf16 v[80:83], v[164:167], v[188:191], v[80:83]
    v_mfma_f32_16x16x32_bf16 v[84:87], v[164:167], v[192:195], v[84:87]
    v_mfma_f32_16x16x32_bf16 v[88:91], v[164:167], v[196:199], v[88:91]
    v_mfma_f32_16x16x32_bf16 v[92:95], v[164:167], v[200:203], v[92:95]
    ds_read_b64_tr_b16 v[164:165], v242 offset:28960
    ds_read_b64_tr_b16 v[166:167], v242 offset:30112
    v_mfma_f32_16x16x32_bf16 v[96:99], v[168:171], v[188:191], v[96:99]
    v_mfma_f32_16x16x32_bf16 v[100:103], v[168:171], v[192:195], v[100:103]
    v_mfma_f32_16x16x32_bf16 v[104:107], v[168:171], v[196:199], v[104:107]
    v_mfma_f32_16x16x32_bf16 v[108:111], v[168:171], v[200:203], v[108:111]
    ds_read_b64_tr_b16 v[168:169], v242 offset:28992
    ds_read_b64_tr_b16 v[170:171], v242 offset:30144
    v_mfma_f32_16x16x32_bf16 v[112:115], v[172:175], v[188:191], v[112:115]
    v_mfma_f32_16x16x32_bf16 v[116:119], v[172:175], v[192:195], v[116:119]
    v_mfma_f32_16x16x32_bf16 v[120:123], v[172:175], v[196:199], v[120:123]
    v_mfma_f32_16x16x32_bf16 v[124:127], v[172:175], v[200:203], v[124:127]
    v_mfma_f32_16x16x32_bf16 v[128:131], v[176:179], v[188:191], v[128:131]
    v_mfma_f32_16x16x32_bf16 v[132:135], v[176:179], v[192:195], v[132:135]
    v_mfma_f32_16x16x32_bf16 v[136:139], v[176:179], v[196:199], v[136:139]
    v_mfma_f32_16x16x32_bf16 v[140:143], v[176:179], v[200:203], v[140:143]
k3_skip_39:
    s_cmp_lt_u32 10, s34
    s_cbranch_scc1 k3w_45
    s_cmp_lt_u32 8, s34
    s_cbranch_scc1 k3w_46
    s_waitcnt vmcnt(0) lgkmcnt(0)
    s_branch k3w_47
k3w_45:
    s_waitcnt vmcnt(9) lgkmcnt(0)
    s_branch k3w_47
k3w_46:
    s_waitcnt vmcnt(4) lgkmcnt(0)
k3w_47:
    s_barrier
    s_cmp_lt_u32 9, s34
    s_cbranch_scc0 k3n_48
    buffer_load_dwordx4 v[188:191], v241, s[16:19], s69 offen
    s_add_u32 s69, s69, 0x400
    buffer_load_dwordx4 v[192:195], v241, s[16:19], s70 offen
    s_add_u32 s70, s70, 0x400
    buffer_load_dwordx4 v[196:199], v241, s[16:19], s71 offen
    s_add_u32 s71, s71, 0x400
    buffer_load_dwordx4 v[200:203], v241, s[16:19], s72 offen
    s_add_u32 s72, s72, 0x400
k3n_48:
    ds_read_b64_tr_b16 v[172:173], v242 offset:224
    ds_read_b64_tr_b16 v[174:175], v242 offset:1376
    ds_read_b64_tr_b16 v[176:177], v242 offset:256
    ds_read_b64_tr_b16 v[178:179], v242 offset:1408
    v_mfma_f32_16x16x32_bf16 v[0:3], v[144:147], v[204:207], v[0:3]
    v_mfma_f32_16x16x32_bf16 v[4:7], v[144:147], v[208:211], v[4:7]
    v_mfma_f32_16x16x32_bf16 v[8:11], v[144:147], v[212:215], v[8:11]
    v_mfma_f32_16x16x32_bf16 v[12:15], v[144:147], v[216:219], v[12:15]
    ds_read_b64_tr_b16 v[144:145], v242 offset:0
    ds_read_b64_tr_b16 v[146:147], v242 offset:1152
    v_mfma_f32_16x16x32_bf16 v[16:19], v[148:151], v[204:207], v[16:19]
    v_mfma_f32_16x16x32_bf16 v[20:23], v[148:151], v[208:211], v[20:23]
    v_mfma_f32_16x16x32_bf16 v[24:27], v[148:151], v[212:215], v[24:27]
    v_mfma_f32_16x16x32_bf16 v[28:31], v[148:151], v[216:219], v[28:31]
    ds_read_b64_tr_b16 v[148:149], v242 offset:32
    ds_read_b64_tr_b16 v[150:151], v242 offset:1184
    v_mfma_f32_16x16x32_bf16 v[32:35], v[152:155], v[204:207], v[32:35]
    v_mfma_f32_16x16x32_bf16 v[36:39], v[152:155], v[208:211], v[36:39]
    v_mfma_f32_16x16x32_bf16 v[40:43], v[152:155], v[212:215], v[40:43]
    v_mfma_f32_16x16x32_bf16 v[44:47], v[152:155], v[216:219], v[44:47]
    ds_read_b64_tr_b16 v[152:153], v242 offset:64
    ds_read_b64_tr_b16 v[154:155], v242 offset:1216
    v_mfma_f32_16x16x32_bf16 v[48:51], v[156:159], v[204:207], v[48:51]
    v_mfma_f32_16x16x32_bf16 v[52:55], v[156:159], v[208:211], v[52:55]
    v_mfma_f32_16x16x32_bf16 v[56:59], v[156:159], v[212:215], v[56:59]
    v_mfma_f32_16x16x32_bf16 v[60:63], v[156:159], v[216:219], v[60:63]
    ds_read_b64_tr_b16 v[156:157], v242 offset:96
    ds_read_b64_tr_b16 v[158:159], v242 offset:1248
    v_mfma_f32_16x16x32_bf16 v[64:67], v[160:163], v[204:207], v[64:67]
    v_mfma_f32_16x16x32_bf16 v[68:71], v[160:163], v[208:211], v[68:71]
    v_mfma_f32_16x16x32_bf16 v[72:75], v[160:163], v[212:215], v[72:75]
    v_mfma_f32_16x16x32_bf16 v[76:79], v[160:163], v[216:219], v[76:79]
    ds_read_b64_tr_b16 v[160:161], v242 offset:128
    ds_read_b64_tr_b16 v[162:163], v242 offset:1280
    v_mfma_f32_16x16x32_bf16 v[80:83], v[164:167], v[204:207], v[80:83]
    v_mfma_f32_16x16x32_bf16 v[84:87], v[164:167], v[208:211], v[84:87]
    v_mfma_f32_16x16x32_bf16 v[88:91], v[164:167], v[212:215], v[88:91]
    v_mfma_f32_16x16x32_bf16 v[92:95], v[164:167], v[216:219], v[92:95]
    ds_read_b64_tr_b16 v[164:165], v242 offset:160
    ds_read_b64_tr_b16 v[166:167], v242 offset:1312
    v_mfma_f32_16x16x32_bf16 v[96:99], v[168:171], v[204:207], v[96:99]
    v_mfma_f32_16x16x32_bf16 v[100:103], v[168:171], v[208:211], v[100:103]
    v_mfma_f32_16x16x32_bf16 v[104:107], v[168:171], v[212:215], v[104:107]
    v_mfma_f32_16x16x32_bf16 v[108:111], v[168:171], v[216:219], v[108:111]
    ds_read_b64_tr_b16 v[168:169], v242 offset:192
    ds_read_b64_tr_b16 v[170:171], v242 offset:1344
    v_mfma_f32_16x16x32_bf16 v[112:115], v[180:183], v[204:207], v[112:115]
    v_mfma_f32_16x16x32_bf16 v[116:119], v[180:183], v[208:211], v[116:119]
    v_mfma_f32_16x16x32_bf16 v[120:123], v[180:183], v[212:215], v[120:123]
    v_mfma_f32_16x16x32_bf16 v[124:127], v[180:183], v[216:219], v[124:127]
    v_mfma_f32_16x16x32_bf16 v[128:131], v[184:187], v[204:207], v[128:131]
    v_mfma_f32_16x16x32_bf16 v[132:135], v[184:187], v[208:211], v[132:135]
    v_mfma_f32_16x16x32_bf16 v[136:139], v[184:187], v[212:215], v[136:139]
    v_mfma_f32_16x16x32_bf16 v[140:143], v[184:187], v[216:219], v[140:143]
k3_skip_44:
    s_cmp_lt_u32 9, s34
    s_cbranch_scc1 k3w_51
    s_waitcnt vmcnt(0) lgkmcnt(0)
    s_branch k3w_52
k3w_50:
    s_waitcnt vmcnt(9) lgkmcnt(0)
    s_branch k3w_52
k3w_51:
    s_waitcnt vmcnt(4) lgkmcnt(0)
k3w_52:
    s_barrier
    s_cmp_lt_u32 10, s34
    s_cbranch_scc0 k3n_53
    buffer_load_dwordx4 v[204:207], v241, s[16:19], s69 offen
    s_add_u32 s69, s69, 0x400
    buffer_load_dwordx4 v[208:211], v241, s[16:19], s70 offen
    s_add_u32 s70, s70, 0x400
    buffer_load_dwordx4 v[212:215], v241, s[16:19], s71 offen
    s_add_u32 s71, s71, 0x400
    buffer_load_dwordx4 v[216:219], v241, s[16:19], s72 offen
    s_add_u32 s72, s72, 0x400
k3n_53:
    ds_read_b64_tr_b16 v[180:181], v242 offset:9824
    ds_read_b64_tr_b16 v[182:183], v242 offset:10976
    ds_read_b64_tr_b16 v[184:185], v242 offset:9856
    ds_read_b64_tr_b16 v[186:187], v242 offset:11008
    v_mfma_f32_16x16x32_bf16 v[0:3], v[144:147], v[220:223], v[0:3]
    v_mfma_f32_16x16x32_bf16 v[4:7], v[144:147], v[224:227], v[4:7]
    v_mfma_f32_16x16x32_bf16 v[8:11], v[144:147], v[228:231], v[8:11]
    v_mfma_f32_16x16x32_bf16 v[12:15], v[144:147], v[232:235], v[12:15]
    ds_read_b64_tr_b16 v[144:145], v242 offset:9600
    ds_read_b64_tr_b16 v[146:147], v242 offset:10752
    v_mfma_f32_16x16x32_bf16 v[16:19], v[148:151], v[220:223], v[16:19]
    v_mfma_f32_16x16x32_bf16 v[20:23], v[148:151], v[224:227], v[20:23]
    v_mfma_f32_16x16x32_bf16 v[24:27], v[148:151], v[228:231], v[24:27]
    v_mfma_f32_16x16x32_bf16 v[28:31], v[148:151], v[232:235], v[28:31]
    ds_read_b64_tr_b16 v[148:149], v242 offset:9632
    ds_read_b64_tr_b16 v[150:151], v242 offset:10784
    v_mfma_f32_16x16x32_bf16 v[32:35], v[152:155], v[220:223], v[32:35]
    v_mfma_f32_16x16x32_bf16 v[36:39], v[152:155], v[224:227], v[36:39]
    v_mfma_f32_16x16x32_bf16 v[40:43], v[152:155], v[228:231], v[40:43]
    v_mfma_f32_16x16x32_bf16 v[44:47], v[152:155], v[232:235], v[44:47]
    ds_read_b64_tr_b16 v[152:153], v242 offset:9664
    ds_read_b64_tr_b16 v[154:155], v242 offset:10816
    v_mfma_f32_16x16x32_bf16 v[48:51], v[156:159], v[220:223], v[48:51]
    v_mfma_f32_16x16x32_bf16 v[52:55], v[156:159], v[224:227], v[52:55]
    v_mfma_f32_16x16x32_bf16 v[56:59], v[156:159], v[228:231], v[56:59]
    v_mfma_f32_16x16x32_bf16 v[60:63], v[156:159], v[232:235], v[60:63]
    ds_read_b64_tr_b16 v[156:157], v242 offset:9696
    ds_read_b64_tr_b16 v[158:159], v242 offset:10848
    v_mfma_f32_16x16x32_bf16 v[64:67], v[160:163], v[220:223], v[64:67]
    v_mfma_f32_16x16x32_bf16 v[68:71], v[160:163], v[224:227], v[68:71]
    v_mfma_f32_16x16x32_bf16 v[72:75], v[160:163], v[228:231], v[72:75]
    v_mfma_f32_16x16x32_bf16 v[76:79], v[160:163], v[232:235], v[76:79]
    ds_read_b64_tr_b16 v[160:161], v242 offset:9728
    ds_read_b64_tr_b16 v[162:163], v242 offset:10880
    v_mfma_f32_16x16x32_bf16 v[80:83], v[164:167], v[220:223], v[80:83]
    v_mfma_f32_16x16x32_bf16 v[84:87], v[164:167], v[224:227], v[84:87]
    v_mfma_f32_16x16x32_bf16 v[88:91], v[164:167], v[228:231], v[88:91]
    v_mfma_f32_16x16x32_bf16 v[92:95], v[164:167], v[232:235], v[92:95]
    ds_read_b64_tr_b16 v[164:165], v242 offset:9760
    ds_read_b64_tr_b16 v[166:167], v242 offset:10912
    v_mfma_f32_16x16x32_bf16 v[96:99], v[168:171], v[220:223], v[96:99]
    v_mfma_f32_16x16x32_bf16 v[100:103], v[168:171], v[224:227], v[100:103]
    v_mfma_f32_16x16x32_bf16 v[104:107], v[168:171], v[228:231], v[104:107]
    v_mfma_f32_16x16x32_bf16 v[108:111], v[168:171], v[232:235], v[108:111]
    ds_read_b64_tr_b16 v[168:169], v242 offset:9792
    ds_read_b64_tr_b16 v[170:171], v242 offset:10944
    v_mfma_f32_16x16x32_bf16 v[112:115], v[172:175], v[220:223], v[112:115]
    v_mfma_f32_16x16x32_bf16 v[116:119], v[172:175], v[224:227], v[116:119]
    v_mfma_f32_16x16x32_bf16 v[120:123], v[172:175], v[228:231], v[120:123]
    v_mfma_f32_16x16x32_bf16 v[124:127], v[172:175], v[232:235], v[124:127]
    v_mfma_f32_16x16x32_bf16 v[128:131], v[176:179], v[220:223], v[128:131]
    v_mfma_f32_16x16x32_bf16 v[132:135], v[176:179], v[224:227], v[132:135]
    v_mfma_f32_16x16x32_bf16 v[136:139], v[176:179], v[228:231], v[136:139]
    v_mfma_f32_16x16x32_bf16 v[140:143], v[176:179], v[232:235], v[140:143]
k3_skip_49:
    s_cmp_lt_u32 10, s34
    s_cbranch_scc1 k3w_56
    s_waitcnt vmcnt(0) lgkmcnt(0)
    s_branch k3w_57
k3w_55:
    s_waitcnt vmcnt(9) lgkmcnt(0)
    s_branch k3w_57
k3w_56:
    s_waitcnt vmcnt(4) lgkmcnt(0)
k3w_57:
    s_barrier
    s_cmp_lt_u32 9, s34
    s_cbranch_scc0 k3_skip_54
    ds_read_b64_tr_b16 v[172:173], v242 offset:19424
    ds_read_b64_tr_b16 v[174:175], v242 offset:20576
    ds_read_b64_tr_b16 v[176:177], v242 offset:19456
    ds_read_b64_tr_b16 v[178:179], v242 offset:20608
    v_mfma_f32_16x16x32_bf16 v[0:3], v[144:147], v[188:191], v[0:3]
    v_mfma_f32_16x16x32_bf16 v[4:7], v[144:147], v[192:195], v[4:7]
    v_mfma_f32_16x16x32_bf16 v[8:11], v[144:147], v[196:199], v[8:11]
    v_mfma_f32_16x16x32_bf16 v[12:15], v[144:147], v[200:203], v[12:15]
    ds_read_b64_tr_b16 v[144:145], v242 offset:19200
    ds_read_b64_tr_b16 v[146:147], v242 offset:20352
    v_mfma_f32_16x16x32_bf16 v[16:19], v[148:151], v[188:191], v[16:19]
    v_mfma_f32_16x16x32_bf16 v[20:23], v[148:151], v[192:195], v[20:23]
    v_mfma_f32_16x16x32_bf16 v[24:27], v[148:151], v[196:199], v[24:27]
    v_mfma_f32_16x16x32_bf16 v[28:31], v[148:151], v[200:203], v[28:31]
    ds_read_b64_tr_b16 v[148:149], v242 offset:19232
    ds_read_b64_tr_b16 v[150:151], v242 offset:20384
    v_mfma_f32_16x16x32_bf16 v[32:35], v[152:155], v[188:191], v[32:35]
    v_mfma_f32_16x16x32_bf16 v[36:39], v[152:155], v[192:195], v[36:39]
    v_mfma_f32_16x16x32_bf16 v[40:43], v[152:155], v[196:199], v[40:43]
    v_mfma_f32_16x16x32_bf16 v[44:47], v[152:155], v[200:203], v[44:47]
    ds_read_b64_tr_b16 v[152:153], v242 offset:19264
    ds_read_b64_tr_b16 v[154:155], v242 offset:20416
    v_mfma_f32_16x16x32_bf16 v[48:51], v[156:159], v[188:191], v[48:51]
    v_mfma_f32_16x16x32_bf16 v[52:55], v[156:159], v[192:195], v[52:55]
    v_mfma_f32_16x16x32_bf16 v[56:59], v[156:159], v[196:199], v[56:59]
    v_mfma_f32_16x16x32_bf16 v[60:63], v[156:159], v[200:203], v[60:63]
    ds_read_b64_tr_b16 v[156:157], v242 offset:19296
    ds_read_b64_tr_b16 v[158:159], v242 offset:20448
    v_mfma_f32_16x16x32_bf16 v[64:67], v[160:163], v[188:191], v[64:67]
    v_mfma_f32_16x16x32_bf16 v[68:71], v[160:163], v[192:195], v[68:71]
    v_mfma_f32_16x16x32_bf16 v[72:75], v[160:163], v[196:199], v[72:75]
    v_mfma_f32_16x16x32_bf16 v[76:79], v[160:163], v[200:203], v[76:79]
    ds_read_b64_tr_b16 v[160:161], v242 offset:19328
    ds_read_b64_tr_b16 v[162:163], v242 offset:20480
    v_mfma_f32_16x16x32_bf16 v[80:83], v[164:167], v[188:191], v[80:83]
    v_mfma_f32_16x16x32_bf16 v[84:87], v[164:167], v[192:195], v[84:87]
    v_mfma_f32_16x16x32_bf16 v[88:91], v[164:167], v[196:199], v[88:91]
    v_mfma_f32_16x16x32_bf16 v[92:95], v[164:167], v[200:203], v[92:95]
    ds_read_b64_tr_b16 v[164:165], v242 offset:19360
    ds_read_b64_tr_b16 v[166:167], v242 offset:20512
    v_mfma_f32_16x16x32_bf16 v[96:99], v[168:171], v[188:191], v[96:99]
    v_mfma_f32_16x16x32_bf16 v[100:103], v[168:171], v[192:195], v[100:103]
    v_mfma_f32_16x16x32_bf16 v[104:107], v[168:171], v[196:199], v[104:107]
    v_mfma_f32_16x16x32_bf16 v[108:111], v[168:171], v[200:203], v[108:111]
    ds_read_b64_tr_b16 v[168:169], v242 offset:19392
    ds_read_b64_tr_b16 v[170:171], v242 offset:20544
    v_mfma_f32_16x16x32_bf16 v[112:115], v[180:183], v[188:191], v[112:115]
    v_mfma_f32_16x16x32_bf16 v[116:119], v[180:183], v[192:195], v[116:119]
    v_mfma_f32_16x16x32_bf16 v[120:123], v[180:183], v[196:199], v[120:123]
    v_mfma_f32_16x16x32_bf16 v[124:127], v[180:183], v[200:203], v[124:127]
    v_mfma_f32_16x16x32_bf16 v[128:131], v[184:187], v[188:191], v[128:131]
    v_mfma_f32_16x16x32_bf16 v[132:135], v[184:187], v[192:195], v[132:135]
    v_mfma_f32_16x16x32_bf16 v[136:139], v[184:187], v[196:199], v[136:139]
    v_mfma_f32_16x16x32_bf16 v[140:143], v[184:187], v[200:203], v[140:143]
k3_skip_54:
    s_waitcnt vmcnt(0) lgkmcnt(0)
    s_branch k3w_61
k3w_59:
    s_waitcnt vmcnt(9) lgkmcnt(0)
    s_branch k3w_61
k3w_60:
    s_waitcnt vmcnt(4) lgkmcnt(0)
k3w_61:
    s_barrier
    s_cmp_lt_u32 10, s34
    s_cbranch_scc0 k3_skip_58
    v_mfma_f32_16x16x32_bf16 v[0:3], v[144:147], v[204:207], v[0:3]
    v_mfma_f32_16x16x32_bf16 v[4:7], v[144:147], v[208:211], v[4:7]
    v_mfma_f32_16x16x32_bf16 v[8:11], v[144:147], v[212:215], v[8:11]
    v_mfma_f32_16x16x32_bf16 v[12:15], v[144:147], v[216:219], v[12:15]
    v_mfma_f32_16x16x32_bf16 v[16:19], v[148:151], v[204:207], v[16:19]
    v_mfma_f32_16x16x32_bf16 v[20:23], v[148:151], v[208:211], v[20:23]
    v_mfma_f32_16x16x32_bf16 v[24:27], v[148:151], v[212:215], v[24:27]
    v_mfma_f32_16x16x32_bf16 v[28:31], v[148:151], v[216:219], v[28:31]
    v_mfma_f32_16x16x32_bf16 v[32:35], v[152:155], v[204:207], v[32:35]
    v_mfma_f32_16x16x32_bf16 v[36:39], v[152:155], v[208:211], v[36:39]
    v_mfma_f32_16x16x32_bf16 v[40:43], v[152:155], v[212:215], v[40:43]
    v_mfma_f32_16x16x32_bf16 v[44:47], v[152:155], v[216:219], v[44:47]
    v_mfma_f32_16x16x32_bf16 v[48:51], v[156:159], v[204:207], v[48:51]
    v_mfma_f32_16x16x32_bf16 v[52:55], v[156:159], v[208:211], v[52:55]
    v_mfma_f32_16x16x32_bf16 v[56:59], v[156:159], v[212:215], v[56:59]
    v_mfma_f32_16x16x32_bf16 v[60:63], v[156:159], v[216:219], v[60:63]
    v_mfma_f32_16x16x32_bf16 v[64:67], v[160:163], v[204:207], v[64:67]
    v_mfma_f32_16x16x32_bf16 v[68:71], v[160:163], v[208:211], v[68:71]
    v_mfma_f32_16x16x32_bf16 v[72:75], v[160:163], v[212:215], v[72:75]
    v_mfma_f32_16x16x32_bf16 v[76:79], v[160:163], v[216:219], v[76:79]
    v_mfma_f32_16x16x32_bf16 v[80:83], v[164:167], v[204:207], v[80:83]
    v_mfma_f32_16x16x32_bf16 v[84:87], v[164:167], v[208:211], v[84:87]
    v_mfma_f32_16x16x32_bf16 v[88:91], v[164:167], v[212:215], v[88:91]
    v_mfma_f32_16x16x32_bf16 v[92:95], v[164:167], v[216:219], v[92:95]
    v_mfma_f32_16x16x32_bf16 v[96:99], v[168:171], v[204:207], v[96:99]
    v_mfma_f32_16x16x32_bf16 v[100:103], v[168:171], v[208:211], v[100:103]
    v_mfma_f32_16x16x32_bf16 v[104:107], v[168:171], v[212:215], v[104:107]
    v_mfma_f32_16x16x32_bf16 v[108:111], v[168:171], v[216:219], v[108:111]
    v_mfma_f32_16x16x32_bf16 v[112:115], v[172:175], v[204:207], v[112:115]
    v_mfma_f32_16x16x32_bf16 v[116:119], v[172:175], v[208:211], v[116:119]
    v_mfma_f32_16x16x32_bf16 v[120:123], v[172:175], v[212:215], v[120:123]
    v_mfma_f32_16x16x32_bf16 v[124:127], v[172:175], v[216:219], v[124:127]
    v_mfma_f32_16x16x32_bf16 v[128:131], v[176:179], v[204:207], v[128:131]
    v_mfma_f32_16x16x32_bf16 v[132:135], v[176:179], v[208:211], v[132:135]
    v_mfma_f32_16x16x32_bf16 v[136:139], v[176:179], v[212:215], v[136:139]
    v_mfma_f32_16x16x32_bf16 v[140:143], v[176:179], v[216:219], v[140:143]
k3_skip_58:
    s_waitcnt vmcnt(0) lgkmcnt(0)
    s_barrier
    v_and_b32 v247, 63, v246
    v_lshlrev_b32 v240, 4, v247
    s_mul_i32 s56, s28, 0x4800
    v_add_u32 v236, s56, v240
    s_xor_b32 s57, s28, 2
    s_mul_i32 s57, s57, 0x4800
    v_add_u32 v237, s57, v240
    v_and_b32 v248, 15, v247
    v_lshrrev_b32 v249, 4, v247
    v_add_u32 v238, s46, v248
    v_mul_u32_u24 v238, 0x480, v238
    v_lshl_add_u32 v239, v249, 3, v238
    v_and_b32 v250, 1, v249
    v_lshl_add_u32 v238, v250, 5, v238
    v_lshrrev_b32 v250, 1, v249
    v_lshl_add_u32 v238, v250, 4, v238
    s_mul_i32 s58, s31, 0x240000
    s_mul_i32 s59, s30, 0x120
    s_add_u32 s58, s58, s59
    s_add_u32 s58, s58, 0x1c00000
    s_and_b32 s59, s26, 1
    s_cmp_eq_u32 s59, 1
    s_cbranch_scc1 k3_v_63
    ds_write_b128 v236, v[8:11] offset:0
    ds_write_b128 v236, v[12:15] offset:1024
    ds_write_b128 v236, v[24:27] offset:2048
    ds_write_b128 v236, v[28:31] offset:3072
    ds_write_b128 v236, v[40:43] offset:4096
    ds_write_b128 v236, v[44:47] offset:5120
    ds_write_b128 v236, v[56:59] offset:6144
    ds_write_b128 v236, v[60:63] offset:7168
    ds_write_b128 v236, v[72:75] offset:8192
    ds_write_b128 v236, v[76:79] offset:9216
    ds_write_b128 v236, v[88:91] offset:10240
    ds_write_b128 v236, v[92:95] offset:11264
    ds_write_b128 v236, v[104:107] offset:12288
    ds_write_b128 v236, v[108:111] offset:13312
    ds_write_b128 v236, v[120:123] offset:14336
    ds_write_b128 v236, v[124:127] offset:15360
    ds_write_b128 v236, v[136:139] offset:16384
    ds_write_b128 v236, v[140:143] offset:17408
    s_waitcnt lgkmcnt(0)
    s_barrier
    ds_read_b128 v[144:147], v237 offset:0
    ds_read_b128 v[148:151], v237 offset:1024
    ds_read_b128 v[152:155], v237 offset:2048
    ds_read_b128 v[156:159], v237 offset:3072
    ds_read_b128 v[160:163], v237 offset:4096
    ds_read_b128 v[164:167], v237 offset:5120
    ds_read_b128 v[168:171], v237 offset:6144
    ds_read_b128 v[172:175], v237 offset:7168
    ds_read_b128 v[176:179], v237 offset:8192
    ds_read_b128 v[180:183], v237 offset:9216
    ds_read_b128 v[184:187], v237 offset:10240
    ds_read_b128 v[188:191], v237 offset:11264
    ds_read_b128 v[192:195], v237 offset:12288
    ds_read_b128 v[196:199], v237 offset:13312
    ds_read_b128 v[200:203], v237 offset:14336
    ds_read_b128 v[204:207], v237 offset:15360
    ds_read_b128 v[208:211], v237 offset:16384
    ds_read_b128 v[212:215], v237 offset:17408
    s_waitcnt lgkmcnt(15)
    v_pk_add_f32 v[0:1], v[0:1], v[144:145]
    v_pk_add_f32 v[2:3], v[2:3], v[146:147]
    s_waitcnt lgkmcnt(15)
    v_pk_add_f32 v[4:5], v[4:5], v[148:149]
    v_pk_add_f32 v[6:7], v[6:7], v[150:151]
    s_waitcnt lgkmcnt(15)
    v_pk_add_f32 v[16:17], v[16:17], v[152:153]
    v_pk_add_f32 v[18:19], v[18:19], v[154:155]
    s_waitcnt lgkmcnt(14)
    v_pk_add_f32 v[20:21], v[20:21], v[156:157]
    v_pk_add_f32 v[22:23], v[22:23], v[158:159]
    s_waitcnt lgkmcnt(13)
    v_pk_add_f32 v[32:33], v[32:33], v[160:161]
    v_pk_add_f32 v[34:35], v[34:35], v[162:163]
    s_waitcnt lgkmcnt(12)
    v_pk_add_f32 v[36:37], v[36:37], v[164:165]
    v_pk_add_f32 v[38:39], v[38:39], v[166:167]
    s_waitcnt lgkmcnt(11)
    v_pk_add_f32 v[48:49], v[48:49], v[168:169]
    v_pk_add_f32 v[50:51], v[50:51], v[170:171]
    s_waitcnt lgkmcnt(10)
    v_pk_add_f32 v[52:53], v[52:53], v[172:173]
    v_pk_add_f32 v[54:55], v[54:55], v[174:175]
    s_waitcnt lgkmcnt(9)
    v_pk_add_f32 v[64:65], v[64:65], v[176:177]
    v_pk_add_f32 v[66:67], v[66:67], v[178:179]
    s_waitcnt lgkmcnt(8)
    v_pk_add_f32 v[68:69], v[68:69], v[180:181]
    v_pk_add_f32 v[70:71], v[70:71], v[182:183]
    s_waitcnt lgkmcnt(7)
    v_pk_add_f32 v[80:81], v[80:81], v[184:185]
    v_pk_add_f32 v[82:83], v[82:83], v[186:187]
    s_waitcnt lgkmcnt(6)
    v_pk_add_f32 v[84:85], v[84:85], v[188:189]
    v_pk_add_f32 v[86:87], v[86:87], v[190:191]
    s_waitcnt lgkmcnt(5)
    v_pk_add_f32 v[96:97], v[96:97], v[192:193]
    v_pk_add_f32 v[98:99], v[98:99], v[194:195]
    s_waitcnt lgkmcnt(4)
    v_pk_add_f32 v[100:101], v[100:101], v[196:197]
    v_pk_add_f32 v[102:103], v[102:103], v[198:199]
    s_waitcnt lgkmcnt(3)
    v_pk_add_f32 v[112:113], v[112:113], v[200:201]
    v_pk_add_f32 v[114:115], v[114:115], v[202:203]
    s_waitcnt lgkmcnt(2)
    v_pk_add_f32 v[116:117], v[116:117], v[204:205]
    v_pk_add_f32 v[118:119], v[118:119], v[206:207]
    s_waitcnt lgkmcnt(1)
    v_pk_add_f32 v[128:129], v[128:129], v[208:209]
    v_pk_add_f32 v[130:131], v[130:131], v[210:211]
    s_waitcnt lgkmcnt(0)
    v_pk_add_f32 v[132:133], v[132:133], v[212:213]
    v_pk_add_f32 v[134:135], v[134:135], v[214:215]
    s_barrier
    s_xor_b32 s57, s28, 4
    s_mul_i32 s57, s57, 0x4800
    v_add_u32 v237, s57, v240
    s_cmp_ge_u32 s26, 2
    s_cbranch_scc1 k3_v_64
    ds_write_b128 v236, v[4:7] offset:0
    ds_write_b128 v236, v[20:23] offset:1024
    ds_write_b128 v236, v[36:39] offset:2048
    ds_write_b128 v236, v[52:55] offset:3072
    ds_write_b128 v236, v[68:71] offset:4096
    ds_write_b128 v236, v[84:87] offset:5120
    ds_write_b128 v236, v[100:103] offset:6144
    ds_write_b128 v236, v[116:119] offset:7168
    ds_write_b128 v236, v[132:135] offset:8192
    s_waitcnt lgkmcnt(0)
    s_barrier
    ds_read_b128 v[144:147], v237 offset:0
    ds_read_b128 v[148:151], v237 offset:1024
    ds_read_b128 v[152:155], v237 offset:2048
    ds_read_b128 v[156:159], v237 offset:3072
    ds_read_b128 v[160:163], v237 offset:4096
    ds_read_b128 v[164:167], v237 offset:5120
    ds_read_b128 v[168:171], v237 offset:6144
    ds_read_b128 v[172:175], v237 offset:7168
    ds_read_b128 v[176:179], v237 offset:8192
    s_add_u32 s60, s58, 0
    s_waitcnt lgkmcnt(7)
    v_pk_add_f32 v[0:1], v[0:1], v[144:145]
    v_pk_add_f32 v[2:3], v[2:3], v[146:147]
    v_cvt_pk_bf16_f32 v220, v0, v1
    v_cvt_pk_bf16_f32 v221, v2, v3
    v_pk_add_f32 v[16:17], v[16:17], v[148:149]
    v_pk_add_f32 v[18:19], v[18:19], v[150:151]
    v_cvt_pk_bf16_f32 v222, v16, v17
    v_cvt_pk_bf16_f32 v223, v18, v19
    s_nop 0
    v_permlane16_swap_b32 v220, v222
    s_nop 0
    v_permlane16_swap_b32 v221, v223
    buffer_store_dwordx4 v[220:223], v238, s[16:19], s60 offen offset:0
    s_waitcnt lgkmcnt(5)
    v_pk_add_f32 v[32:33], v[32:33], v[152:153]
    v_pk_add_f32 v[34:35], v[34:35], v[154:155]
    v_cvt_pk_bf16_f32 v220, v32, v33
    v_cvt_pk_bf16_f32 v221, v34, v35
    v_pk_add_f32 v[48:49], v[48:49], v[156:157]
    v_pk_add_f32 v[50:51], v[50:51], v[158:159]
    v_cvt_pk_bf16_f32 v222, v48, v49
    v_cvt_pk_bf16_f32 v223, v50, v51
    s_nop 0
    v_permlane16_swap_b32 v220, v222
    s_nop 0
    v_permlane16_swap_b32 v221, v223
    buffer_store_dwordx4 v[220:223], v238, s[16:19], s60 offen offset:64
    s_waitcnt lgkmcnt(3)
    v_pk_add_f32 v[64:65], v[64:65], v[160:161]
    v_pk_add_f32 v[66:67], v[66:67], v[162:163]
    v_cvt_pk_bf16_f32 v220, v64, v65
    v_cvt_pk_bf16_f32 v221, v66, v67
    v_pk_add_f32 v[80:81], v[80:81], v[164:165]
    v_pk_add_f32 v[82:83], v[82:83], v[166:167]
    v_cvt_pk_bf16_f32 v222, v80, v81
    v_cvt_pk_bf16_f32 v223, v82, v83
    s_nop 0
    v_permlane16_swap_b32 v220, v222
    s_nop 0
    v_permlane16_swap_b32 v221, v223
    buffer_store_dwordx4 v[220:223], v238, s[16:19], s60 offen offset:128
    s_waitcnt lgkmcnt(1)
    v_pk_add_f32 v[96:97], v[96:97], v[168:169]
    v_pk_add_f32 v[98:99], v[98:99], v[170:171]
    v_cvt_pk_bf16_f32 v220, v96, v97
    v_cvt_pk_bf16_f32 v221, v98, v99
    v_pk_add_f32 v[112:113], v[112:113], v[172:173]
    v_pk_add_f32 v[114:115], v[114:115], v[174:175]
    v_cvt_pk_bf16_f32 v222, v112, v113
    v_cvt_pk_bf16_f32 v223, v114, v115
    s_nop 0
    v_permlane16_swap_b32 v220, v222
    s_nop 0
    v_permlane16_swap_b32 v221, v223
    buffer_store_dwordx4 v[220:223], v238, s[16:19], s60 offen offset:192
    s_waitcnt lgkmcnt(0)
    v_pk_add_f32 v[128:129], v[128:129], v[176:177]
    v_pk_add_f32 v[130:131], v[130:131], v[178:179]
    v_cvt_pk_bf16_f32 v220, v128, v129
    v_cvt_pk_bf16_f32 v221, v130, v131
    buffer_store_dwordx2 v[220:221], v239, s[16:19], s60 offen offset:256
    s_waitcnt vmcnt(0)
    s_waitcnt lgkmcnt(0)
    s_endpgm
k3_v_64:
    ds_write_b128 v236, v[0:3] offset:0
    ds_write_b128 v236, v[16:19] offset:1024
    ds_write_b128 v236, v[32:35] offset:2048
    ds_write_b128 v236, v[48:51] offset:3072
    ds_write_b128 v236, v[64:67] offset:4096
    ds_write_b128 v236, v[80:83] offset:5120
    ds_write_b128 v236, v[96:99] offset:6144
    ds_write_b128 v236, v[112:115] offset:7168
    ds_write_b128 v236, v[128:131] offset:8192
    s_waitcnt lgkmcnt(0)
    s_barrier
    ds_read_b128 v[144:147], v237 offset:0
    ds_read_b128 v[148:151], v237 offset:1024
    ds_read_b128 v[152:155], v237 offset:2048
    ds_read_b128 v[156:159], v237 offset:3072
    ds_read_b128 v[160:163], v237 offset:4096
    ds_read_b128 v[164:167], v237 offset:5120
    ds_read_b128 v[168:171], v237 offset:6144
    ds_read_b128 v[172:175], v237 offset:7168
    ds_read_b128 v[176:179], v237 offset:8192
    s_add_u32 s60, s58, 0x4800
    s_waitcnt lgkmcnt(7)
    v_pk_add_f32 v[4:5], v[4:5], v[144:145]
    v_pk_add_f32 v[6:7], v[6:7], v[146:147]
    v_cvt_pk_bf16_f32 v220, v4, v5
    v_cvt_pk_bf16_f32 v221, v6, v7
    v_pk_add_f32 v[20:21], v[20:21], v[148:149]
    v_pk_add_f32 v[22:23], v[22:23], v[150:151]
    v_cvt_pk_bf16_f32 v222, v20, v21
    v_cvt_pk_bf16_f32 v223, v22, v23
    s_nop 0
    v_permlane16_swap_b32 v220, v222
    s_nop 0
    v_permlane16_swap_b32 v221, v223
    buffer_store_dwordx4 v[220:223], v238, s[16:19], s60 offen offset:0
    s_waitcnt lgkmcnt(5)
    v_pk_add_f32 v[36:37], v[36:37], v[152:153]
    v_pk_add_f32 v[38:39], v[38:39], v[154:155]
    v_cvt_pk_bf16_f32 v220, v36, v37
    v_cvt_pk_bf16_f32 v221, v38, v39
    v_pk_add_f32 v[52:53], v[52:53], v[156:157]
    v_pk_add_f32 v[54:55], v[54:55], v[158:159]
    v_cvt_pk_bf16_f32 v222, v52, v53
    v_cvt_pk_bf16_f32 v223, v54, v55
    s_nop 0
    v_permlane16_swap_b32 v220, v222
    s_nop 0
    v_permlane16_swap_b32 v221, v223
    buffer_store_dwordx4 v[220:223], v238, s[16:19], s60 offen offset:64
    s_waitcnt lgkmcnt(3)
    v_pk_add_f32 v[68:69], v[68:69], v[160:161]
    v_pk_add_f32 v[70:71], v[70:71], v[162:163]
    v_cvt_pk_bf16_f32 v220, v68, v69
    v_cvt_pk_bf16_f32 v221, v70, v71
    v_pk_add_f32 v[84:85], v[84:85], v[164:165]
    v_pk_add_f32 v[86:87], v[86:87], v[166:167]
    v_cvt_pk_bf16_f32 v222, v84, v85
    v_cvt_pk_bf16_f32 v223, v86, v87
    s_nop 0
    v_permlane16_swap_b32 v220, v222
    s_nop 0
    v_permlane16_swap_b32 v221, v223
    buffer_store_dwordx4 v[220:223], v238, s[16:19], s60 offen offset:128
    s_waitcnt lgkmcnt(1)
    v_pk_add_f32 v[100:101], v[100:101], v[168:169]
    v_pk_add_f32 v[102:103], v[102:103], v[170:171]
    v_cvt_pk_bf16_f32 v220, v100, v101
    v_cvt_pk_bf16_f32 v221, v102, v103
    v_pk_add_f32 v[116:117], v[116:117], v[172:173]
    v_pk_add_f32 v[118:119], v[118:119], v[174:175]
    v_cvt_pk_bf16_f32 v222, v116, v117
    v_cvt_pk_bf16_f32 v223, v118, v119
    s_nop 0
    v_permlane16_swap_b32 v220, v222
    s_nop 0
    v_permlane16_swap_b32 v221, v223
    buffer_store_dwordx4 v[220:223], v238, s[16:19], s60 offen offset:192
    s_waitcnt lgkmcnt(0)
    v_pk_add_f32 v[132:133], v[132:133], v[176:177]
    v_pk_add_f32 v[134:135], v[134:135], v[178:179]
    v_cvt_pk_bf16_f32 v220, v132, v133
    v_cvt_pk_bf16_f32 v221, v134, v135
    buffer_store_dwordx2 v[220:221], v239, s[16:19], s60 offen offset:256
    s_waitcnt vmcnt(0)
    s_waitcnt lgkmcnt(0)
    s_endpgm
k3_v_63:
    ds_write_b128 v236, v[0:3] offset:0
    ds_write_b128 v236, v[4:7] offset:1024
    ds_write_b128 v236, v[16:19] offset:2048
    ds_write_b128 v236, v[20:23] offset:3072
    ds_write_b128 v236, v[32:35] offset:4096
    ds_write_b128 v236, v[36:39] offset:5120
    ds_write_b128 v236, v[48:51] offset:6144
    ds_write_b128 v236, v[52:55] offset:7168
    ds_write_b128 v236, v[64:67] offset:8192
    ds_write_b128 v236, v[68:71] offset:9216
    ds_write_b128 v236, v[80:83] offset:10240
    ds_write_b128 v236, v[84:87] offset:11264
    ds_write_b128 v236, v[96:99] offset:12288
    ds_write_b128 v236, v[100:103] offset:13312
    ds_write_b128 v236, v[112:115] offset:14336
    ds_write_b128 v236, v[116:119] offset:15360
    ds_write_b128 v236, v[128:131] offset:16384
    ds_write_b128 v236, v[132:135] offset:17408
    s_waitcnt lgkmcnt(0)
    s_barrier
    ds_read_b128 v[144:147], v237 offset:0
    ds_read_b128 v[148:151], v237 offset:1024
    ds_read_b128 v[152:155], v237 offset:2048
    ds_read_b128 v[156:159], v237 offset:3072
    ds_read_b128 v[160:163], v237 offset:4096
    ds_read_b128 v[164:167], v237 offset:5120
    ds_read_b128 v[168:171], v237 offset:6144
    ds_read_b128 v[172:175], v237 offset:7168
    ds_read_b128 v[176:179], v237 offset:8192
    ds_read_b128 v[180:183], v237 offset:9216
    ds_read_b128 v[184:187], v237 offset:10240
    ds_read_b128 v[188:191], v237 offset:11264
    ds_read_b128 v[192:195], v237 offset:12288
    ds_read_b128 v[196:199], v237 offset:13312
    ds_read_b128 v[200:203], v237 offset:14336
    ds_read_b128 v[204:207], v237 offset:15360
    ds_read_b128 v[208:211], v237 offset:16384
    ds_read_b128 v[212:215], v237 offset:17408
    s_waitcnt lgkmcnt(15)
    v_pk_add_f32 v[8:9], v[8:9], v[144:145]
    v_pk_add_f32 v[10:11], v[10:11], v[146:147]
    s_waitcnt lgkmcnt(15)
    v_pk_add_f32 v[12:13], v[12:13], v[148:149]
    v_pk_add_f32 v[14:15], v[14:15], v[150:151]
    s_waitcnt lgkmcnt(15)
    v_pk_add_f32 v[24:25], v[24:25], v[152:153]
    v_pk_add_f32 v[26:27], v[26:27], v[154:155]
    s_waitcnt lgkmcnt(14)
    v_pk_add_f32 v[28:29], v[28:29], v[156:157]
    v_pk_add_f32 v[30:31], v[30:31], v[158:159]
    s_waitcnt lgkmcnt(13)
    v_pk_add_f32 v[40:41], v[40:41], v[160:161]
    v_pk_add_f32 v[42:43], v[42:43], v[162:163]
    s_waitcnt lgkmcnt(12)
    v_pk_add_f32 v[44:45], v[44:45], v[164:165]
    v_pk_add_f32 v[46:47], v[46:47], v[166:167]
    s_waitcnt lgkmcnt(11)
    v_pk_add_f32 v[56:57], v[56:57], v[168:169]
    v_pk_add_f32 v[58:59], v[58:59], v[170:171]
    s_waitcnt lgkmcnt(10)
    v_pk_add_f32 v[60:61], v[60:61], v[172:173]
    v_pk_add_f32 v[62:63], v[62:63], v[174:175]
    s_waitcnt lgkmcnt(9)
    v_pk_add_f32 v[72:73], v[72:73], v[176:177]
    v_pk_add_f32 v[74:75], v[74:75], v[178:179]
    s_waitcnt lgkmcnt(8)
    v_pk_add_f32 v[76:77], v[76:77], v[180:181]
    v_pk_add_f32 v[78:79], v[78:79], v[182:183]
    s_waitcnt lgkmcnt(7)
    v_pk_add_f32 v[88:89], v[88:89], v[184:185]
    v_pk_add_f32 v[90:91], v[90:91], v[186:187]
    s_waitcnt lgkmcnt(6)
    v_pk_add_f32 v[92:93], v[92:93], v[188:189]
    v_pk_add_f32 v[94:95], v[94:95], v[190:191]
    s_waitcnt lgkmcnt(5)
    v_pk_add_f32 v[104:105], v[104:105], v[192:193]
    v_pk_add_f32 v[106:107], v[106:107], v[194:195]
    s_waitcnt lgkmcnt(4)
    v_pk_add_f32 v[108:109], v[108:109], v[196:197]
    v_pk_add_f32 v[110:111], v[110:111], v[198:199]
    s_waitcnt lgkmcnt(3)
    v_pk_add_f32 v[120:121], v[120:121], v[200:201]
    v_pk_add_f32 v[122:123], v[122:123], v[202:203]
    s_waitcnt lgkmcnt(2)
    v_pk_add_f32 v[124:125], v[124:125], v[204:205]
    v_pk_add_f32 v[126:127], v[126:127], v[206:207]
    s_waitcnt lgkmcnt(1)
    v_pk_add_f32 v[136:137], v[136:137], v[208:209]
    v_pk_add_f32 v[138:139], v[138:139], v[210:211]
    s_waitcnt lgkmcnt(0)
    v_pk_add_f32 v[140:141], v[140:141], v[212:213]
    v_pk_add_f32 v[142:143], v[142:143], v[214:215]
    s_barrier
    s_xor_b32 s57, s28, 4
    s_mul_i32 s57, s57, 0x4800
    v_add_u32 v237, s57, v240
    s_cmp_ge_u32 s26, 2
    s_cbranch_scc1 k3_v_65
    ds_write_b128 v236, v[12:15] offset:0
    ds_write_b128 v236, v[28:31] offset:1024
    ds_write_b128 v236, v[44:47] offset:2048
    ds_write_b128 v236, v[60:63] offset:3072
    ds_write_b128 v236, v[76:79] offset:4096
    ds_write_b128 v236, v[92:95] offset:5120
    ds_write_b128 v236, v[108:111] offset:6144
    ds_write_b128 v236, v[124:127] offset:7168
    ds_write_b128 v236, v[140:143] offset:8192
    s_waitcnt lgkmcnt(0)
    s_barrier
    ds_read_b128 v[144:147], v237 offset:0
    ds_read_b128 v[148:151], v237 offset:1024
    ds_read_b128 v[152:155], v237 offset:2048
    ds_read_b128 v[156:159], v237 offset:3072
    ds_read_b128 v[160:163], v237 offset:4096
    ds_read_b128 v[164:167], v237 offset:5120
    ds_read_b128 v[168:171], v237 offset:6144
    ds_read_b128 v[172:175], v237 offset:7168
    ds_read_b128 v[176:179], v237 offset:8192
    s_add_u32 s60, s58, 0x9000
    s_waitcnt lgkmcnt(7)
    v_pk_add_f32 v[8:9], v[8:9], v[144:145]
    v_pk_add_f32 v[10:11], v[10:11], v[146:147]
    v_cvt_pk_bf16_f32 v220, v8, v9
    v_cvt_pk_bf16_f32 v221, v10, v11
    v_pk_add_f32 v[24:25], v[24:25], v[148:149]
    v_pk_add_f32 v[26:27], v[26:27], v[150:151]
    v_cvt_pk_bf16_f32 v222, v24, v25
    v_cvt_pk_bf16_f32 v223, v26, v27
    s_nop 0
    v_permlane16_swap_b32 v220, v222
    s_nop 0
    v_permlane16_swap_b32 v221, v223
    buffer_store_dwordx4 v[220:223], v238, s[16:19], s60 offen offset:0
    s_waitcnt lgkmcnt(5)
    v_pk_add_f32 v[40:41], v[40:41], v[152:153]
    v_pk_add_f32 v[42:43], v[42:43], v[154:155]
    v_cvt_pk_bf16_f32 v220, v40, v41
    v_cvt_pk_bf16_f32 v221, v42, v43
    v_pk_add_f32 v[56:57], v[56:57], v[156:157]
    v_pk_add_f32 v[58:59], v[58:59], v[158:159]
    v_cvt_pk_bf16_f32 v222, v56, v57
    v_cvt_pk_bf16_f32 v223, v58, v59
    s_nop 0
    v_permlane16_swap_b32 v220, v222
    s_nop 0
    v_permlane16_swap_b32 v221, v223
    buffer_store_dwordx4 v[220:223], v238, s[16:19], s60 offen offset:64
    s_waitcnt lgkmcnt(3)
    v_pk_add_f32 v[72:73], v[72:73], v[160:161]
    v_pk_add_f32 v[74:75], v[74:75], v[162:163]
    v_cvt_pk_bf16_f32 v220, v72, v73
    v_cvt_pk_bf16_f32 v221, v74, v75
    v_pk_add_f32 v[88:89], v[88:89], v[164:165]
    v_pk_add_f32 v[90:91], v[90:91], v[166:167]
    v_cvt_pk_bf16_f32 v222, v88, v89
    v_cvt_pk_bf16_f32 v223, v90, v91
    s_nop 0
    v_permlane16_swap_b32 v220, v222
    s_nop 0
    v_permlane16_swap_b32 v221, v223
    buffer_store_dwordx4 v[220:223], v238, s[16:19], s60 offen offset:128
    s_waitcnt lgkmcnt(1)
    v_pk_add_f32 v[104:105], v[104:105], v[168:169]
    v_pk_add_f32 v[106:107], v[106:107], v[170:171]
    v_cvt_pk_bf16_f32 v220, v104, v105
    v_cvt_pk_bf16_f32 v221, v106, v107
    v_pk_add_f32 v[120:121], v[120:121], v[172:173]
    v_pk_add_f32 v[122:123], v[122:123], v[174:175]
    v_cvt_pk_bf16_f32 v222, v120, v121
    v_cvt_pk_bf16_f32 v223, v122, v123
    s_nop 0
    v_permlane16_swap_b32 v220, v222
    s_nop 0
    v_permlane16_swap_b32 v221, v223
    buffer_store_dwordx4 v[220:223], v238, s[16:19], s60 offen offset:192
    s_waitcnt lgkmcnt(0)
    v_pk_add_f32 v[136:137], v[136:137], v[176:177]
    v_pk_add_f32 v[138:139], v[138:139], v[178:179]
    v_cvt_pk_bf16_f32 v220, v136, v137
    v_cvt_pk_bf16_f32 v221, v138, v139
    buffer_store_dwordx2 v[220:221], v239, s[16:19], s60 offen offset:256
    s_waitcnt vmcnt(0)
    s_waitcnt lgkmcnt(0)
    s_endpgm
k3_v_65:
    ds_write_b128 v236, v[8:11] offset:0
    ds_write_b128 v236, v[24:27] offset:1024
    ds_write_b128 v236, v[40:43] offset:2048
    ds_write_b128 v236, v[56:59] offset:3072
    ds_write_b128 v236, v[72:75] offset:4096
    ds_write_b128 v236, v[88:91] offset:5120
    ds_write_b128 v236, v[104:107] offset:6144
    ds_write_b128 v236, v[120:123] offset:7168
    ds_write_b128 v236, v[136:139] offset:8192
    s_waitcnt lgkmcnt(0)
    s_barrier
    ds_read_b128 v[144:147], v237 offset:0
    ds_read_b128 v[148:151], v237 offset:1024
    ds_read_b128 v[152:155], v237 offset:2048
    ds_read_b128 v[156:159], v237 offset:3072
    ds_read_b128 v[160:163], v237 offset:4096
    ds_read_b128 v[164:167], v237 offset:5120
    ds_read_b128 v[168:171], v237 offset:6144
    ds_read_b128 v[172:175], v237 offset:7168
    ds_read_b128 v[176:179], v237 offset:8192
    s_add_u32 s60, s58, 0xd800
    s_waitcnt lgkmcnt(7)
    v_pk_add_f32 v[12:13], v[12:13], v[144:145]
    v_pk_add_f32 v[14:15], v[14:15], v[146:147]
    v_cvt_pk_bf16_f32 v220, v12, v13
    v_cvt_pk_bf16_f32 v221, v14, v15
    v_pk_add_f32 v[28:29], v[28:29], v[148:149]
    v_pk_add_f32 v[30:31], v[30:31], v[150:151]
    v_cvt_pk_bf16_f32 v222, v28, v29
    v_cvt_pk_bf16_f32 v223, v30, v31
    s_nop 0
    v_permlane16_swap_b32 v220, v222
    s_nop 0
    v_permlane16_swap_b32 v221, v223
    buffer_store_dwordx4 v[220:223], v238, s[16:19], s60 offen offset:0
    s_waitcnt lgkmcnt(5)
    v_pk_add_f32 v[44:45], v[44:45], v[152:153]
    v_pk_add_f32 v[46:47], v[46:47], v[154:155]
    v_cvt_pk_bf16_f32 v220, v44, v45
    v_cvt_pk_bf16_f32 v221, v46, v47
    v_pk_add_f32 v[60:61], v[60:61], v[156:157]
    v_pk_add_f32 v[62:63], v[62:63], v[158:159]
    v_cvt_pk_bf16_f32 v222, v60, v61
    v_cvt_pk_bf16_f32 v223, v62, v63
    s_nop 0
    v_permlane16_swap_b32 v220, v222
    s_nop 0
    v_permlane16_swap_b32 v221, v223
    buffer_store_dwordx4 v[220:223], v238, s[16:19], s60 offen offset:64
    s_waitcnt lgkmcnt(3)
    v_pk_add_f32 v[76:77], v[76:77], v[160:161]
    v_pk_add_f32 v[78:79], v[78:79], v[162:163]
    v_cvt_pk_bf16_f32 v220, v76, v77
    v_cvt_pk_bf16_f32 v221, v78, v79
    v_pk_add_f32 v[92:93], v[92:93], v[164:165]
    v_pk_add_f32 v[94:95], v[94:95], v[166:167]
    v_cvt_pk_bf16_f32 v222, v92, v93
    v_cvt_pk_bf16_f32 v223, v94, v95
    s_nop 0
    v_permlane16_swap_b32 v220, v222
    s_nop 0
    v_permlane16_swap_b32 v221, v223
    buffer_store_dwordx4 v[220:223], v238, s[16:19], s60 offen offset:128
    s_waitcnt lgkmcnt(1)
    v_pk_add_f32 v[108:109], v[108:109], v[168:169]
    v_pk_add_f32 v[110:111], v[110:111], v[170:171]
    v_cvt_pk_bf16_f32 v220, v108, v109
    v_cvt_pk_bf16_f32 v221, v110, v111
    v_pk_add_f32 v[124:125], v[124:125], v[172:173]
    v_pk_add_f32 v[126:127], v[126:127], v[174:175]
    v_cvt_pk_bf16_f32 v222, v124, v125
    v_cvt_pk_bf16_f32 v223, v126, v127
    s_nop 0
    v_permlane16_swap_b32 v220, v222
    s_nop 0
    v_permlane16_swap_b32 v221, v223
    buffer_store_dwordx4 v[220:223], v238, s[16:19], s60 offen offset:192
    s_waitcnt lgkmcnt(0)
    v_pk_add_f32 v[140:141], v[140:141], v[176:177]
    v_pk_add_f32 v[142:143], v[142:143], v[178:179]
    v_cvt_pk_bf16_f32 v220, v140, v141
    v_cvt_pk_bf16_f32 v221, v142, v143
    buffer_store_dwordx2 v[220:221], v239, s[16:19], s60 offen offset:256
    s_waitcnt vmcnt(0)
    s_waitcnt lgkmcnt(0)
    s_endpgm
k3_end_31:
    s_endpgm
.globl k4_kernel
.p2align 8
.type k4_kernel,@function
k4_kernel:
    s_cmp_ge_u32 s2, 0x240
    s_cbranch_scc1 k4_end_66
    s_load_dwordx2 s[4:5], s[0:1], 0
    s_load_dwordx4 s[8:11], s[0:1], 0x48
    s_load_dwordx2 s[12:13], s[0:1], 0x60
    s_lshl_b32 s3, s2, 8
    v_add_u32 v1, s3, v0
    v_lshlrev_b32 v2, 4, v1
    s_mov_b32 s14, 0x38e38e4
    v_mul_hi_u32 v4, v1, s14
    v_mul_u32_u24 v4, 0x48, v4
    v_sub_u32 v4, v1, v4
    v_lshlrev_b32 v4, 4, v4
    s_waitcnt lgkmcnt(0)
    s_mov_b32 s16, s4
    s_and_b32 s17, s5, 0xffff
    s_mov_b32 s18, 0x240000
    s_mov_b32 s19, 0x20000
    s_mov_b32 s20, s8
    s_and_b32 s21, s9, 0xffff
    s_mov_b32 s22, 0x480
    s_mov_b32 s23, 0x20000
    s_mov_b32 s24, s10
    s_and_b32 s25, s11, 0xffff
    s_mov_b32 s26, 0x240000
    s_mov_b32 s27, 0x20000
    s_mov_b32 s28, s12
    s_and_b32 s29, s13, 0xffff
    s_mov_b32 s30, 0x10000000
    s_mov_b32 s31, 0x20000
    s_mov_b32 s32, 0x1c00000
    buffer_load_dwordx4 v[16:19], v2, s[28:31], s32 offen
    s_mov_b32 s33, 0x1e40000
    buffer_load_dwordx4 v[20:23], v2, s[28:31], s33 offen
    s_mov_b32 s34, 0x2080000
    buffer_load_dwordx4 v[24:27], v2, s[28:31], s34 offen
    s_mov_b32 s35, 0x22c0000
    buffer_load_dwordx4 v[28:31], v2, s[28:31], s35 offen
    buffer_load_dwordx4 v[32:35], v2, s[16:19], 0 offen
    buffer_load_dwordx4 v[36:39], v4, s[20:23], 0 offen
    s_waitcnt vmcnt(5)
    v_lshlrev_b32 v40, 16, v16
    v_and_b32 v41, 0xffff0000, v16
    v_lshlrev_b32 v42, 16, v17
    v_and_b32 v43, 0xffff0000, v17
    v_lshlrev_b32 v44, 16, v18
    v_and_b32 v45, 0xffff0000, v18
    v_lshlrev_b32 v46, 16, v19
    v_and_b32 v47, 0xffff0000, v19
    s_waitcnt vmcnt(4)
    v_lshlrev_b32 v5, 16, v20
    v_and_b32 v6, 0xffff0000, v20
    v_add_f32 v40, v40, v5
    v_add_f32 v41, v41, v6
    v_lshlrev_b32 v5, 16, v21
    v_and_b32 v6, 0xffff0000, v21
    v_add_f32 v42, v42, v5
    v_add_f32 v43, v43, v6
    v_lshlrev_b32 v5, 16, v22
    v_and_b32 v6, 0xffff0000, v22
    v_add_f32 v44, v44, v5
    v_add_f32 v45, v45, v6
    v_lshlrev_b32 v5, 16, v23
    v_and_b32 v6, 0xffff0000, v23
    v_add_f32 v46, v46, v5
    v_add_f32 v47, v47, v6
    s_waitcnt vmcnt(3)
    v_lshlrev_b32 v5, 16, v24
    v_and_b32 v6, 0xffff0000, v24
    v_add_f32 v40, v40, v5
    v_add_f32 v41, v41, v6
    v_lshlrev_b32 v5, 16, v25
    v_and_b32 v6, 0xffff0000, v25
    v_add_f32 v42, v42, v5
    v_add_f32 v43, v43, v6
    v_lshlrev_b32 v5, 16, v26
    v_and_b32 v6, 0xffff0000, v26
    v_add_f32 v44, v44, v5
    v_add_f32 v45, v45, v6
    v_lshlrev_b32 v5, 16, v27
    v_and_b32 v6, 0xffff0000, v27
    v_add_f32 v46, v46, v5
    v_add_f32 v47, v47, v6
    s_waitcnt vmcnt(2)
    v_lshlrev_b32 v5, 16, v28
    v_and_b32 v6, 0xffff0000, v28
    v_add_f32 v40, v40, v5
    v_add_f32 v41, v41, v6
    v_lshlrev_b32 v5, 16, v29
    v_and_b32 v6, 0xffff0000, v29
    v_add_f32 v42, v42, v5
    v_add_f32 v43, v43, v6
    v_lshlrev_b32 v5, 16, v30
    v_and_b32 v6, 0xffff0000, v30
    v_add_f32 v44, v44, v5
    v_add_f32 v45, v45, v6
    v_lshlrev_b32 v5, 16, v31
    v_and_b32 v6, 0xffff0000, v31
    v_add_f32 v46, v46, v5
    v_add_f32 v47, v47, v6
    s_waitcnt vmcnt(1)
    v_lshlrev_b32 v5, 16, v32
    v_and_b32 v6, 0xffff0000, v32
    v_add_f32 v40, v40, v5
    v_add_f32 v41, v41, v6
    v_lshlrev_b32 v5, 16, v33
    v_and_b32 v6, 0xffff0000, v33
    v_add_f32 v42, v42, v5
    v_add_f32 v43, v43, v6
    v_lshlrev_b32 v5, 16, v34
    v_and_b32 v6, 0xffff0000, v34
    v_add_f32 v44, v44, v5
    v_add_f32 v45, v45, v6
    v_lshlrev_b32 v5, 16, v35
    v_and_b32 v6, 0xffff0000, v35
    v_add_f32 v46, v46, v5
    v_add_f32 v47, v47, v6
    s_waitcnt vmcnt(0)
    v_lshlrev_b32 v5, 16, v36
    v_and_b32 v6, 0xffff0000, v36
    v_add_f32 v40, v40, v5
    v_add_f32 v41, v41, v6
    v_lshlrev_b32 v5, 16, v37
    v_and_b32 v6, 0xffff0000, v37
    v_add_f32 v42, v42, v5
    v_add_f32 v43, v43, v6
    v_lshlrev_b32 v5, 16, v38
    v_and_b32 v6, 0xffff0000, v38
    v_add_f32 v44, v44, v5
    v_add_f32 v45, v45, v6
    v_lshlrev_b32 v5, 16, v39
    v_and_b32 v6, 0xffff0000, v39
    v_add_f32 v46, v46, v5
    v_add_f32 v47, v47, v6
    v_cvt_pk_bf16_f32 v8, v40, v41
    v_cvt_pk_bf16_f32 v9, v42, v43
    v_cvt_pk_bf16_f32 v10, v44, v45
    v_cvt_pk_bf16_f32 v11, v46, v47
    buffer_store_dwordx4 v[8:11], v2, s[24:27], 0 offen
k4_end_66:
    s_endpgm
.section .rodata,"a"
.p2align 6
.amdhsa_kernel k1_kernel
  .amdhsa_next_free_vgpr 256
  .amdhsa_next_free_sgpr 102
  .amdhsa_accum_offset 256
  .amdhsa_group_segment_fixed_size 0
  .amdhsa_kernarg_size 104
  .amdhsa_user_sgpr_count 2
  .amdhsa_user_sgpr_kernarg_segment_ptr 1
  .amdhsa_system_sgpr_workgroup_id_x 1
.end_amdhsa_kernel
.p2align 6
.amdhsa_kernel k2_kernel
  .amdhsa_next_free_vgpr 256
  .amdhsa_next_free_sgpr 102
  .amdhsa_accum_offset 256
  .amdhsa_group_segment_fixed_size 0
  .amdhsa_kernarg_size 104
  .amdhsa_user_sgpr_count 2
  .amdhsa_user_sgpr_kernarg_segment_ptr 1
  .amdhsa_system_sgpr_workgroup_id_x 1
.end_amdhsa_kernel
.p2align 6
.amdhsa_kernel k3_kernel
  .amdhsa_next_free_vgpr 256
  .amdhsa_next_free_sgpr 102
  .amdhsa_accum_offset 256
  .amdhsa_group_segment_fixed_size 0
  .amdhsa_kernarg_size 104
  .amdhsa_user_sgpr_count 2
  .amdhsa_user_sgpr_kernarg_segment_ptr 1
  .amdhsa_system_sgpr_workgroup_id_x 1
.end_amdhsa_kernel
.p2align 6
.amdhsa_kernel k4_kernel
  .amdhsa_next_free_vgpr 48
  .amdhsa_next_free_sgpr 102
  .amdhsa_accum_offset 48
  .amdhsa_group_segment_fixed_size 0
  .amdhsa_kernarg_size 104
  .amdhsa_user_sgpr_count 2
  .amdhsa_user_sgpr_kernarg_segment_ptr 1
  .amdhsa_system_sgpr_workgroup_id_x 1
.end_amdhsa_kernel
```
